```python
import torch

def _softmax(x, axis=-1):
    return torch.softmax(x, dim=axis)
def _gelu(x):
    return torch.nn.functional.gelu(x, approximate="tanh")
def _silu(x):
    return torch.nn.functional.silu(x)
def _sigmoid(x):
    return torch.sigmoid(x)
def _layernorm(x, axis=-1, eps=1e-5):
    m = x.mean(dim=axis, keepdim=True)
    v = x.var(dim=axis, keepdim=True, unbiased=False)
    return (x - m) / torch.sqrt(v + eps)
def _scatter_add(tgt, idx, src, axis=0):
    return tgt.clone().index_add_(axis, idx, src)
def _segment_sum(src, seg, n):
    out = torch.zeros((n,) + src.shape[1:], dtype=src.dtype)
    return out.index_add_(0, seg, src)
def _pad(x, pw):
    flat = tuple(v for pair in reversed(pw) for v in pair)
    return torch.nn.functional.pad(x, flat)

kernel_name = 'gated_mix__sliding_block_cached__gqa_block_cached__decode'

def setup_inputs():

    _w = (lambda a: (lambda t: t.to(torch.bfloat16) if t.is_floating_point() else t)(torch.as_tensor(a)))
    def _A_setup():
        B, Sq, D = 2, 1, 512
        Hq, Hkv, Sk, Dh = 32, 8, 32768, 128
        assert Hq % Hkv == 0, (Hq, Hkv)
        return {
            "x": _w((lambda *s: torch.randn(*s, dtype=torch.bfloat16) * 0.05)(B, Sq, D)),
            "k_cache": _w((lambda *s: torch.randn(*s, dtype=torch.bfloat16) * 6.4)(B, Hkv, Sk, Dh)),
            "v_cache": _w((lambda *s: torch.randn(*s, dtype=torch.bfloat16) * 0.05)(B, Hkv, Sk, Dh)),
            "wq": _w((lambda *s: torch.randn(*s, dtype=torch.bfloat16) * 6.4)(D, Hq * Dh) * (D ** -0.5)),
            "wo": _w((lambda *s: torch.randn(*s, dtype=torch.bfloat16) * 0.05)(Hq * Dh, D) * ((Hq * Dh) ** -0.5)),
        }
    _A_in = _A_setup()

    def _B_setup():
        B, Sq, D = 2, 1, 512
        Hq, Hkv, Sk, Dh = 32, 8, 32768, 128
        assert Hq % Hkv == 0, (Hq, Hkv)
        return {
            "x": _w((lambda *s: torch.randn(*s, dtype=torch.bfloat16) * 0.05)(B, Sq, D)),
            "k_cache": _w((lambda *s: torch.randn(*s, dtype=torch.bfloat16) * 6.4)(B, Hkv, Sk, Dh)),
            "v_cache": _w((lambda *s: torch.randn(*s, dtype=torch.bfloat16) * 0.05)(B, Hkv, Sk, Dh)),
            "wq": _w((lambda *s: torch.randn(*s, dtype=torch.bfloat16) * 6.4)(D, Hq * Dh) * (D ** -0.5)),
            "wo": _w((lambda *s: torch.randn(*s, dtype=torch.bfloat16) * 0.05)(Hq * Dh, D) * ((Hq * Dh) ** -0.5)),
        }
    _B_in = _B_setup()

    return {
        "A_x": _A_in["x"],
        "A_k_cache": _A_in["k_cache"],
        "A_v_cache": _A_in["v_cache"],
        "A_wq": _A_in["wq"],
        "A_wo": _A_in["wo"],
        "B_x": _B_in["x"],
        "B_k_cache": _B_in["k_cache"],
        "B_v_cache": _B_in["v_cache"],
        "B_wq": _B_in["wq"],
        "B_wo": _B_in["wo"],
        "gate_w": _w((lambda *s: torch.randn(*s, dtype=torch.bfloat16) * 0.05)(512) * 16.0),
    }

def reference(A_x, A_k_cache, A_v_cache, A_wq, A_wo, B_x, B_k_cache, B_v_cache, B_wq, B_wo, gate_w):
    def _A_ref(x, k_cache, v_cache, wq, wo):
        B, Sq, D = x.shape
        Hq, Dh = 32, 128
        Hkv, Sk = k_cache.shape[1], k_cache.shape[2]
        W = min(4096, max(256, Sk // 4))
        rep = Hq // Hkv
        q = (lambda x, *d: x.permute(*d))((x @ wq).reshape(B, Sq, Hq, Dh), 0, 2, 1, 3)
        k = (lambda x, n, axis: torch.repeat_interleave(x, n, dim=axis))(k_cache[:, :, Sk - W:, :], rep, axis=1)
        v = (lambda x, n, axis: torch.repeat_interleave(x, n, dim=axis))(v_cache[:, :, Sk - W:, :], rep, axis=1)
        scores = torch.einsum("bhqd,bhkd->bhqk", q, k) * (Dh ** -0.5)
        p = _softmax(scores, axis=-1)
        o = torch.einsum("bhqk,bhkd->bhqd", p, v)
        return (lambda x, *d: x.permute(*d))(o, 0, 2, 1, 3).reshape(B, Sq, Hq * Dh) @ wo

    def _B_ref(x, k_cache, v_cache, wq, wo):
        B, Sq, D = x.shape
        Hq, Dh = 32, 128
        Hkv = k_cache.shape[1]
        rep = Hq // Hkv
        q = (lambda x, *d: x.permute(*d))((x @ wq).reshape(B, Sq, Hq, Dh), 0, 2, 1, 3)
        k = (lambda x, n, axis: torch.repeat_interleave(x, n, dim=axis))(k_cache, rep, axis=1)
        v = (lambda x, n, axis: torch.repeat_interleave(x, n, dim=axis))(v_cache, rep, axis=1)
        scores = torch.einsum("bhqd,bhkd->bhqk", q, k) * (Dh ** -0.5)
        p = _softmax(scores, axis=-1)
        o = torch.einsum("bhqk,bhkd->bhqd", p, v)
        return (lambda x, *d: x.permute(*d))(o, 0, 2, 1, 3).reshape(B, Sq, Hq * Dh) @ wo

    x = A_x
    g = _sigmoid((x * gate_w).sum(-1, keepdims=True))
    a = _A_ref(x, A_k_cache, A_v_cache, A_wq, A_wo)
    b = _B_ref(x, B_k_cache, B_v_cache, B_wq, B_wo)
    return g * a + (1 - g) * b
```

```asm
; @launch grid=(256,1,1) block=(256,1,1) lds=56384
.amdgcn_target "amdgcn-amd-amdhsa--gfx950"
.text
.globl gated_mix__sliding_block_cached__gqa_block_cached__decode_kernel
.p2align 8
.type gated_mix__sliding_block_cached__gqa_block_cached__decode_kernel,@function
gated_mix__sliding_block_cached__gqa_block_cached__decode_kernel:
    s_cmp_ge_u32 s2, 256
    s_cbranch_scc1 L_end
    s_load_dwordx16 s[48:63], s[0:1], 0
    s_load_dwordx8 s[64:71], s[0:1], 64
    s_load_dwordx4 s[72:75], s[0:1], 96
    v_lshrrev_b32 v33, 6, v0
    v_and_b32 v3, 63, v0
    s_lshr_b32 s45, s2, 4
    v_readfirstlane_b32 s44, v33
    s_and_b32 s46, s2, 15
    s_lshr_b32 s47, s45, 3
    s_and_b32 s76, s45, 7
    v_lshrrev_b32 v33, 2, v3
    v_lshlrev_b32 v34, 16, v33
    v_and_b32 v35, 3, v3
    v_lshl_add_u32 v34, v35, 4, v34
    v_lshlrev_b32 v71, 4, v33
    s_and_b32 s85, s46, 7
    s_lshl_b32 s85, s85, 7
    s_lshr_b32 s86, s46, 3
    s_lshl_b32 s86, s86, 6
    s_add_u32 s85, s85, s86
    s_lshl_b32 s86, s76, 10
    s_add_u32 s86, s86, s85
    s_lshl_b32 s87, s44, 20
    s_add_u32 s86, s86, s87
    s_lshl_b32 s87, s44, 8
    v_lshlrev_b32 v2, 4, v3
    v_lshrrev_b32 v1, 4, v3
    v_lshlrev_b32 v1, 6, v1
    v_lshl_add_u32 v1, v35, 4, v1
    v_bfe_u32 v33, v3, 2, 2
    v_lshl_add_u32 v1, v33, 8, v1
    v_mov_b32 v0, v1
    s_lshl_b32 s88, s45, 23
    s_lshl_b32 s81, s46, 16
    s_add_u32 s81, s81, 7340032
    s_lshl_b32 s80, s44, 12
    s_add_u32 s81, s81, s80
    s_add_u32 s80, s81, 16384
    s_cmp_eq_u32 s47, 0
    s_waitcnt lgkmcnt(0)
    s_cselect_b64 s[24:25], s[54:55], s[64:65]
    s_cselect_b64 s[28:29], s[56:57], s[66:67]
    s_mov_b32 s26, 0x400000
    s_mov_b32 s27, 0x20000
    s_mov_b64 s[36:37], s[48:49]
    s_mov_b32 s38, 2048
    s_mov_b32 s39, 0x20000
    buffer_load_dwordx4 v[12:15], v71, s[36:39], s87 offen
    buffer_load_dwordx4 v[16:19], v71, s[36:39], s87 offen offset:1024
    buffer_load_dwordx4 v[200:203], v34, s[24:27], s86 offen nt
    s_add_u32 s86, s86, 8192
    buffer_load_dwordx4 v[204:207], v34, s[24:27], s86 offen nt
    s_add_u32 s86, s86, 8192
    buffer_load_dwordx4 v[208:211], v34, s[24:27], s86 offen nt
    s_add_u32 s86, s86, 8192
    buffer_load_dwordx4 v[212:215], v34, s[24:27], s86 offen nt
    s_add_u32 s86, s86, 8192
    buffer_load_dwordx4 v[216:219], v34, s[24:27], s86 offen nt
    s_add_u32 s86, s86, 8192
    buffer_load_dwordx4 v[220:223], v34, s[24:27], s86 offen nt
    s_add_u32 s86, s86, 8192
    buffer_load_dwordx4 v[224:227], v34, s[24:27], s86 offen nt
    s_add_u32 s86, s86, 8192
    buffer_load_dwordx4 v[228:231], v34, s[24:27], s86 offen nt
    s_load_dword s83, s[74:75], 0
    s_add_u32 s12, s60, s88
    s_addc_u32 s13, s61, 0
    s_add_u32 s14, s50, s88
    s_addc_u32 s15, s51, 0
    s_add_u32 s16, s62, s88
    s_addc_u32 s17, s63, 0
    s_add_u32 s18, s52, s88
    s_addc_u32 s19, s53, 0
    s_mov_b64 s[8:9], s[14:15]
    s_mov_b32 s10, 0x800000
    s_mov_b32 s11, 0x20000
    s_getpc_b64 s[52:53]
L_pc:
    s_mov_b32 s54, L_end-L_pc
    s_mov_b32 s55, 0x20000
    v_mov_b32 v70, 56336
    v_mov_b32 v28, 0
    v_mov_b32 v29, 20
    ds_write_b64 v70, v[28:29]
    v_mov_b32 v36, 0x7fc0dead
    v_mov_b32 v37, 0x7fc0dead
    v_mov_b32 v38, 0x7fc0dead
    v_mov_b32 v39, 0x7fc0dead
    s_mul_i32 s86, s44, 9216
    v_add_u32 v70, s86, v2
    ds_write_b128 v70, v[36:39] offset:0
    ds_write_b128 v70, v[36:39] offset:1024
    ds_write_b128 v70, v[36:39] offset:2048
    ds_write_b128 v70, v[36:39] offset:3072
    ds_write_b128 v70, v[36:39] offset:4096
    ds_write_b128 v70, v[36:39] offset:5120
    ds_write_b128 v70, v[36:39] offset:6144
    ds_write_b128 v70, v[36:39] offset:7168
    ds_write_b128 v70, v[36:39] offset:8192
    s_mov_b64 s[32:33], s[74:75]
    s_mov_b32 s34, 4194304
    s_mov_b32 s35, 0x20000
    s_mov_b32 s77, 0x3e0293ee
    s_mov_b32 s30, 0x400000
    s_mov_b32 s31, 0x20000
    s_mov_b64 s[40:41], s[70:71]
    s_mov_b32 s42, 2048
    s_mov_b32 s43, 0x20000
    s_mov_b32 s89, 0x0c0c0400
    s_mov_b32 s90, 0x04000c0c
    s_mov_b32 s91, 0xffffff00
    s_mov_b32 s92, 0x11111111
    s_mov_b32 s93, 0x11111111
    s_mov_b32 s78, 0
    s_mov_b32 s56, 0
    s_mov_b32 s58, 72
    s_mov_b32 s59, 0
    s_mov_b32 s84, 1048576
    s_lshr_b32 s7, s2, 3
    s_xor_b32 s7, s7, s2
    s_and_b32 s7, s7, 7
    s_lshl_b32 s64, s46, 19
    s_lshl_b32 s65, s46, 16
    s_add_u32 s65, s65, 7340032
    s_mov_b32 s66, 0
    v_and_b32 v33, 1, v3
    v_lshlrev_b32 v33, 4, v33
    v_mov_b32 v31, 0xffff
    v_lshlrev_b32 v31, v33, v31
    v_and_b32 v33, 2, v3
    v_cmp_eq_u32 vcc, 0, v33
    v_mov_b32 v64, 56340
    v_mov_b32 v30, 0xff7fffff
    v_cndmask_b32 v32, v31, 0, vcc
    v_cndmask_b32 v31, 0, v31, vcc
    v_lshrrev_b32 v33, 5, v3
    v_lshlrev_b32 v33, 7, v33
    v_lshl_add_u32 v33, v35, 5, v33
    v_and_b32 v34, 16, v3
    s_lshl_b32 s86, s44, 8
    v_add3_u32 v33, v33, v34, s86
    s_waitcnt lgkmcnt(0)
    s_barrier
    s_mul_i32 s83, s83, 0x9e3779b1
    s_add_u32 s83, s83, 0x7f4a7c15
    s_or_b32 s83, s83, 1
    v_mov_b32 v68, s83
    v_mov_b32 v28, 0xff7fffff
    v_mov_b32 v29, 0
    s_waitcnt vmcnt(7)
    v_lshlrev_b32 v36, 16, v12
    v_and_b32 v37, 0xffff0000, v12
    v_lshlrev_b32 v38, 16, v13
    v_and_b32 v39, 0xffff0000, v13
    v_lshlrev_b32 v40, 16, v14
    v_and_b32 v41, 0xffff0000, v14
    v_lshlrev_b32 v42, 16, v15
    v_and_b32 v43, 0xffff0000, v15
    v_lshlrev_b32 v44, 16, v16
    v_and_b32 v45, 0xffff0000, v16
    v_lshlrev_b32 v46, 16, v17
    v_and_b32 v47, 0xffff0000, v17
    v_lshlrev_b32 v48, 16, v18
    v_and_b32 v49, 0xffff0000, v18
    v_lshlrev_b32 v50, 16, v19
    v_and_b32 v51, 0xffff0000, v19
    buffer_load_dwordx4 v[72:75], v0, s[8:11], s81 offen offset:0 nt
    v_lshlrev_b32 v20, 16, v200
    v_and_b32 v21, 0xffff0000, v200
    v_mul_f32 v232, v20, v36
    v_mul_f32 v233, v21, v36
    v_mul_f32 v240, v20, v44
    v_mul_f32 v241, v21, v44
    v_lshlrev_b32 v22, 16, v201
    v_and_b32 v23, 0xffff0000, v201
    v_mul_f32 v234, v22, v36
    v_mul_f32 v235, v23, v36
    v_mul_f32 v242, v22, v44
    v_mul_f32 v243, v23, v44
    v_lshlrev_b32 v20, 16, v202
    v_and_b32 v21, 0xffff0000, v202
    v_mul_f32 v236, v20, v36
    v_mul_f32 v237, v21, v36
    v_mul_f32 v244, v20, v44
    v_mul_f32 v245, v21, v44
    v_lshlrev_b32 v22, 16, v203
    v_and_b32 v23, 0xffff0000, v203
    v_mul_f32 v238, v22, v36
    v_mul_f32 v239, v23, v36
    v_mul_f32 v246, v22, v44
    v_mul_f32 v247, v23, v44
    s_waitcnt vmcnt(7)
    buffer_load_dwordx4 v[76:79], v0, s[8:11], s81 offen offset:1024 nt
    v_lshlrev_b32 v20, 16, v204
    v_and_b32 v21, 0xffff0000, v204
    v_fmac_f32 v232, v20, v37
    v_fmac_f32 v233, v21, v37
    v_fmac_f32 v240, v20, v45
    v_fmac_f32 v241, v21, v45
    v_lshlrev_b32 v22, 16, v205
    v_and_b32 v23, 0xffff0000, v205
    v_fmac_f32 v234, v22, v37
    v_fmac_f32 v235, v23, v37
    v_fmac_f32 v242, v22, v45
    v_fmac_f32 v243, v23, v45
    v_lshlrev_b32 v20, 16, v206
    v_and_b32 v21, 0xffff0000, v206
    v_fmac_f32 v236, v20, v37
    v_fmac_f32 v237, v21, v37
    v_fmac_f32 v244, v20, v45
    v_fmac_f32 v245, v21, v45
    v_lshlrev_b32 v22, 16, v207
    v_and_b32 v23, 0xffff0000, v207
    v_fmac_f32 v238, v22, v37
    v_fmac_f32 v239, v23, v37
    v_fmac_f32 v246, v22, v45
    v_fmac_f32 v247, v23, v45
    s_waitcnt vmcnt(7)
    buffer_load_dwordx4 v[80:83], v0, s[8:11], s81 offen offset:2048 nt
    v_lshlrev_b32 v20, 16, v208
    v_and_b32 v21, 0xffff0000, v208
    v_fmac_f32 v232, v20, v38
    v_fmac_f32 v233, v21, v38
    v_fmac_f32 v240, v20, v46
    v_fmac_f32 v241, v21, v46
    v_lshlrev_b32 v22, 16, v209
    v_and_b32 v23, 0xffff0000, v209
    v_fmac_f32 v234, v22, v38
    v_fmac_f32 v235, v23, v38
    v_fmac_f32 v242, v22, v46
    v_fmac_f32 v243, v23, v46
    v_lshlrev_b32 v20, 16, v210
    v_and_b32 v21, 0xffff0000, v210
    v_fmac_f32 v236, v20, v38
    v_fmac_f32 v237, v21, v38
    v_fmac_f32 v244, v20, v46
    v_fmac_f32 v245, v21, v46
    v_lshlrev_b32 v22, 16, v211
    v_and_b32 v23, 0xffff0000, v211
    v_fmac_f32 v238, v22, v38
    v_fmac_f32 v239, v23, v38
    v_fmac_f32 v246, v22, v46
    v_fmac_f32 v247, v23, v46
    s_waitcnt vmcnt(7)
    buffer_load_dwordx4 v[84:87], v0, s[8:11], s81 offen offset:3072 nt
    v_lshlrev_b32 v20, 16, v212
    v_and_b32 v21, 0xffff0000, v212
    v_fmac_f32 v232, v20, v39
    v_fmac_f32 v233, v21, v39
    v_fmac_f32 v240, v20, v47
    v_fmac_f32 v241, v21, v47
    v_lshlrev_b32 v22, 16, v213
    v_and_b32 v23, 0xffff0000, v213
    v_fmac_f32 v234, v22, v39
    v_fmac_f32 v235, v23, v39
    v_fmac_f32 v242, v22, v47
    v_fmac_f32 v243, v23, v47
    v_lshlrev_b32 v20, 16, v214
    v_and_b32 v21, 0xffff0000, v214
    v_fmac_f32 v236, v20, v39
    v_fmac_f32 v237, v21, v39
    v_fmac_f32 v244, v20, v47
    v_fmac_f32 v245, v21, v47
    v_lshlrev_b32 v22, 16, v215
    v_and_b32 v23, 0xffff0000, v215
    v_fmac_f32 v238, v22, v39
    v_fmac_f32 v239, v23, v39
    v_fmac_f32 v246, v22, v47
    v_fmac_f32 v247, v23, v47
    s_waitcnt vmcnt(7)
    buffer_load_dwordx4 v[88:91], v0, s[8:11], s80 offen offset:0 nt
    v_lshlrev_b32 v20, 16, v216
    v_and_b32 v21, 0xffff0000, v216
    v_fmac_f32 v232, v20, v40
    v_fmac_f32 v233, v21, v40
    v_fmac_f32 v240, v20, v48
    v_fmac_f32 v241, v21, v48
    v_lshlrev_b32 v22, 16, v217
    v_and_b32 v23, 0xffff0000, v217
    v_fmac_f32 v234, v22, v40
    v_fmac_f32 v235, v23, v40
    v_fmac_f32 v242, v22, v48
    v_fmac_f32 v243, v23, v48
    v_lshlrev_b32 v20, 16, v218
    v_and_b32 v21, 0xffff0000, v218
    v_fmac_f32 v236, v20, v40
    v_fmac_f32 v237, v21, v40
    v_fmac_f32 v244, v20, v48
    v_fmac_f32 v245, v21, v48
    v_lshlrev_b32 v22, 16, v219
    v_and_b32 v23, 0xffff0000, v219
    v_fmac_f32 v238, v22, v40
    v_fmac_f32 v239, v23, v40
    v_fmac_f32 v246, v22, v48
    v_fmac_f32 v247, v23, v48
    s_waitcnt vmcnt(7)
    buffer_load_dwordx4 v[92:95], v0, s[8:11], s80 offen offset:1024 nt
    v_lshlrev_b32 v20, 16, v220
    v_and_b32 v21, 0xffff0000, v220
    v_fmac_f32 v232, v20, v41
    v_fmac_f32 v233, v21, v41
    v_fmac_f32 v240, v20, v49
    v_fmac_f32 v241, v21, v49
    v_lshlrev_b32 v22, 16, v221
    v_and_b32 v23, 0xffff0000, v221
    v_fmac_f32 v234, v22, v41
    v_fmac_f32 v235, v23, v41
    v_fmac_f32 v242, v22, v49
    v_fmac_f32 v243, v23, v49
    v_lshlrev_b32 v20, 16, v222
    v_and_b32 v21, 0xffff0000, v222
    v_fmac_f32 v236, v20, v41
    v_fmac_f32 v237, v21, v41
    v_fmac_f32 v244, v20, v49
    v_fmac_f32 v245, v21, v49
    v_lshlrev_b32 v22, 16, v223
    v_and_b32 v23, 0xffff0000, v223
    v_fmac_f32 v238, v22, v41
    v_fmac_f32 v239, v23, v41
    v_fmac_f32 v246, v22, v49
    v_fmac_f32 v247, v23, v49
    s_waitcnt vmcnt(7)
    buffer_load_dwordx4 v[96:99], v0, s[8:11], s80 offen offset:2048 nt
    v_lshlrev_b32 v20, 16, v224
    v_and_b32 v21, 0xffff0000, v224
    v_fmac_f32 v232, v20, v42
    v_fmac_f32 v233, v21, v42
    v_fmac_f32 v240, v20, v50
    v_fmac_f32 v241, v21, v50
    v_lshlrev_b32 v22, 16, v225
    v_and_b32 v23, 0xffff0000, v225
    v_fmac_f32 v234, v22, v42
    v_fmac_f32 v235, v23, v42
    v_fmac_f32 v242, v22, v50
    v_fmac_f32 v243, v23, v50
    v_lshlrev_b32 v20, 16, v226
    v_and_b32 v21, 0xffff0000, v226
    v_fmac_f32 v236, v20, v42
    v_fmac_f32 v237, v21, v42
    v_fmac_f32 v244, v20, v50
    v_fmac_f32 v245, v21, v50
    v_lshlrev_b32 v22, 16, v227
    v_and_b32 v23, 0xffff0000, v227
    v_fmac_f32 v238, v22, v42
    v_fmac_f32 v239, v23, v42
    v_fmac_f32 v246, v22, v50
    v_fmac_f32 v247, v23, v50
    s_waitcnt vmcnt(7)
    buffer_load_dwordx4 v[100:103], v0, s[8:11], s80 offen offset:3072 nt
    v_lshlrev_b32 v20, 16, v228
    v_and_b32 v21, 0xffff0000, v228
    v_fmac_f32 v232, v20, v43
    v_fmac_f32 v233, v21, v43
    v_fmac_f32 v240, v20, v51
    v_fmac_f32 v241, v21, v51
    v_lshlrev_b32 v22, 16, v229
    v_and_b32 v23, 0xffff0000, v229
    v_fmac_f32 v234, v22, v43
    v_fmac_f32 v235, v23, v43
    v_fmac_f32 v242, v22, v51
    v_fmac_f32 v243, v23, v51
    v_lshlrev_b32 v20, 16, v230
    v_and_b32 v21, 0xffff0000, v230
    v_fmac_f32 v236, v20, v43
    v_fmac_f32 v237, v21, v43
    v_fmac_f32 v244, v20, v51
    v_fmac_f32 v245, v21, v51
    v_lshlrev_b32 v22, 16, v231
    v_and_b32 v23, 0xffff0000, v231
    v_fmac_f32 v238, v22, v43
    v_fmac_f32 v239, v23, v43
    v_fmac_f32 v246, v22, v51
    v_fmac_f32 v247, v23, v51
    s_nop 1
    v_permlane32_swap_b32 v232, v240
    v_permlane32_swap_b32 v233, v241
    v_permlane32_swap_b32 v234, v242
    v_permlane32_swap_b32 v235, v243
    v_permlane32_swap_b32 v236, v244
    v_permlane32_swap_b32 v237, v245
    v_permlane32_swap_b32 v238, v246
    v_permlane32_swap_b32 v239, v247
    v_add_f32 v232, v232, v240
    v_add_f32 v233, v233, v241
    v_add_f32 v234, v234, v242
    v_add_f32 v235, v235, v243
    v_add_f32 v236, v236, v244
    v_add_f32 v237, v237, v245
    v_add_f32 v238, v238, v246
    v_add_f32 v239, v239, v247
    s_add_u32 s81, s81, 32768
    s_add_u32 s80, s80, 32768
    buffer_load_dwordx4 v[104:107], v0, s[8:11], s81 offen offset:0 nt
    s_nop 1
    v_permlane16_swap_b32 v232, v236
    v_permlane16_swap_b32 v233, v237
    v_permlane16_swap_b32 v234, v238
    v_permlane16_swap_b32 v235, v239
    v_add_f32 v232, v232, v236
    v_add_f32 v233, v233, v237
    v_add_f32 v234, v234, v238
    v_add_f32 v235, v235, v239
    s_nop 1
    v_add_f32_dpp v232, v232, v232 row_ror:8 row_mask:0xf bank_mask:0xf
    v_add_f32_dpp v233, v233, v233 row_ror:8 row_mask:0xf bank_mask:0xf
    v_add_f32_dpp v234, v234, v234 row_ror:8 row_mask:0xf bank_mask:0xf
    v_add_f32_dpp v235, v235, v235 row_ror:8 row_mask:0xf bank_mask:0xf
    s_nop 1
    v_add_f32_dpp v232, v232, v232 row_ror:4 row_mask:0xf bank_mask:0xf
    v_add_f32_dpp v233, v233, v233 row_ror:4 row_mask:0xf bank_mask:0xf
    v_add_f32_dpp v234, v234, v234 row_ror:4 row_mask:0xf bank_mask:0xf
    v_add_f32_dpp v235, v235, v235 row_ror:4 row_mask:0xf bank_mask:0xf
    s_mov_b32 exec_lo, 0x000f000f
    s_mov_b32 exec_hi, 0x000f000f
    ds_write_b128 v33, v[232:235] offset:54528
    s_mov_b64 exec, 1
    v_mov_b32 v33, 56336
    v_mov_b32 v34, 1
    s_waitcnt lgkmcnt(0)
    ds_add_rtn_u32 v34, v33, v34
    s_mov_b64 exec, -1
    buffer_load_dwordx4 v[108:111], v0, s[8:11], s81 offen offset:1024 nt
    s_cmp_lg_u32 s44, 3
    s_cbranch_scc1 Lnopf_1
    v_lshlrev_b32 v70, 7, v3
    s_movk_i32 s86, 0x2000
    buffer_load_dword v66, v70, s[52:55], 0 offen
    buffer_load_dword v67, v70, s[52:55], s86 offen
    s_movk_i32 s86, 0x4000
    buffer_load_dword v67, v70, s[52:55], s86 offen
Lnopf_1:
    s_waitcnt lgkmcnt(0)
    buffer_load_dwordx4 v[112:115], v0, s[8:11], s81 offen offset:2048 nt
    v_readfirstlane_b32 s86, v34
    v_lshlrev_b32 v33, 2, v3
    s_nop 2
    s_cmp_lg_u32 s86, 3
    s_cbranch_scc1 Lnosvc_2
    ds_read_b32 v232, v33 offset:54528
    ds_read_b32 v233, v33 offset:54784
    ds_read_b32 v234, v33 offset:55040
    ds_read_b32 v235, v33 offset:55296
    s_mul_i32 s86, s47, 32768
    s_lshl_b32 s87, s76, 11
    s_add_u32 s86, s86, s87
    s_lshl_b32 s87, s85, 1
    s_add_u32 s86, s86, s87
    s_add_u32 s86, s86, 65536
    v_lshrrev_b32 v34, 5, v3
    v_lshlrev_b32 v34, 14, v34
    v_and_b32 v33, 31, v3
    v_lshl_add_u32 v34, v33, 2, v34
    s_waitcnt lgkmcnt(0)
    v_add_f32 v232, v232, v233
    v_add_f32 v234, v234, v235
    v_add_f32 v232, v232, v234
    v_mov_b32 v245, v68
    v_mov_b32 v247, v68
    v_mov_b32_dpp v233, v232 quad_perm:[1,1,3,3] row_mask:0xf bank_mask:0xf
    s_nop 0
    v_cvt_pk_bf16_f32 v244, v232, v233
    s_nop 1
    v_mov_b32_dpp v246, v244 quad_perm:[2,2,2,2] row_mask:0xf bank_mask:0xf
    s_mov_b64 exec, s[92:93]
    buffer_store_dwordx4 v[244:247], v34, s[32:35], s86 offen sc1
    s_mov_b64 exec, -1
Lnosvc_2:
    v_lshlrev_b32 v33, 1, v1
    s_lshl_b32 s86, s45, 11
    s_add_u32 s86, s86, 65536
    s_add_u32 s87, s86, 32768
    v_mov_b32 v56, 0
    v_mov_b32 v232, 0
    v_mov_b32 v57, 0
    v_mov_b32 v233, 0
    v_mov_b32 v58, 0
    v_mov_b32 v234, 0
    v_mov_b32 v59, 0
    v_mov_b32 v235, 0
    v_mov_b32 v60, 0
    v_mov_b32 v236, 0
    v_mov_b32 v61, 0
    v_mov_b32 v237, 0
    v_mov_b32 v62, 0
    v_mov_b32 v238, 0
    v_mov_b32 v63, 0
    v_mov_b32 v239, 0
    v_mov_b32 v240, 0xff7fffff
    v_mov_b32 v241, 0
    v_mov_b32 v242, 0xff7fffff
    s_add_u32 s20, s44, 64
    s_add_u32 s21, s44, 68
    s_add_u32 s22, s44, 0
    s_add_u32 s23, s44, 4
    s_add_u32 s24, s44, 8
    s_waitcnt vmcnt(5)
    buffer_load_dwordx4 v[116:119], v0, s[8:11], s81 offen offset:3072 nt
    s_waitcnt vmcnt(5)
    buffer_load_dwordx4 v[120:123], v0, s[8:11], s80 offen offset:0 nt
    s_waitcnt vmcnt(5)
    buffer_load_dwordx4 v[124:127], v0, s[8:11], s80 offen offset:1024 nt
    s_waitcnt vmcnt(5)
    buffer_load_dwordx4 v[128:131], v0, s[8:11], s80 offen offset:2048 nt
    s_waitcnt vmcnt(5)
    buffer_load_dwordx4 v[132:135], v0, s[8:11], s80 offen offset:3072 nt
    s_mov_b64 exec, 1
    v_mov_b32 v70, s64
    global_load_dword v66, v70, s[16:17] nt
    v_mov_b32 v34, s65
    global_load_dword v67, v34, s[18:19] nt
    s_mov_b64 exec, -1
    s_waitcnt vmcnt(5)
    s_mov_b64 s[8:9], s[12:13]
    s_lshl_b32 s81, s46, 19
    s_lshl_b32 s80, s44, 12
    s_add_u32 s81, s81, s80
    s_add_u32 s80, s81, 16384
    buffer_load_dwordx4 v[136:139], v0, s[8:11], s81 offen offset:0 nt
    s_lshl_b32 s48, s76, 19
    s_lshl_b32 s49, s46, 15
    s_add_u32 s48, s48, s49
    s_lshl_b32 s49, s44, 8
    s_add_u32 s48, s48, s49
    s_add_u32 s49, s48, 4096
    v_lshrrev_b32 v248, 4, v3
    v_lshlrev_b32 v248, 13, v248
    v_and_b32 v34, 15, v3
    v_lshl_add_u32 v248, v34, 4, v248
    v_bfe_u32 v249, v3, 2, 2
    v_lshlrev_b32 v249, 5, v249
    s_lshl_b32 s88, s44, 3
    v_add_u32 v249, s88, v249
    s_waitcnt vmcnt(5)
    buffer_load_dwordx4 v[140:143], v0, s[8:11], s81 offen offset:1024 nt
    s_lshr_b32 s85, s44, 1
    s_and_b32 s3, s44, 1
    s_lshl_b32 s88, s85, 7
    v_bfe_u32 v251, v3, 3, 2
    v_lshlrev_b32 v251, 5, v251
    v_add_u32 v251, s88, v251
    s_mul_i32 s88, s85, 8704
    s_lshl_b32 s50, s3, 9
    s_add_u32 s88, s88, s50
    v_lshrrev_b32 v250, 3, v3
    v_lshlrev_b32 v250, 6, v250
    v_and_b32 v34, 3, v3
    v_lshl_add_u32 v250, v34, 4, v250
    v_bfe_u32 v34, v3, 2, 1
    v_mul_u32_u24 v34, 1088, v34
    v_add3_u32 v250, v250, v34, s88
    s_lshl_b32 s88, s85, 8
    s_add_u32 s88, s88, s2
    s_lshl_b32 s50, s88, 11
    s_lshl_b32 s51, s3, 10
    s_add_u32 s50, s50, s51
    s_add_u32 s50, s50, 262144
    s_lshl_b32 s51, s88, 7
    s_add_u32 s51, s51, 131072
    s_waitcnt vmcnt(5)
    buffer_load_dwordx4 v[144:147], v0, s[8:11], s81 offen offset:2048 nt
    s_lshr_b32 s85, s44, 1
    s_lshl_b32 s85, s85, 7
    s_lshl_b32 s88, s47, 8
    s_add_u32 s85, s85, s88
    s_lshl_b32 s88, s76, 4
    s_add_u32 s85, s85, s88
    s_and_b32 s60, s46, 3
    s_lshl_b32 s60, s60, 9
    s_lshr_b32 s88, s46, 2
    s_lshl_b32 s61, s88, 7
    s_add_u32 s60, s60, s61
    s_lshl_b32 s61, s85, 11
    s_add_u32 s60, s60, s61
    s_add_u32 s60, s60, 262144
    s_add_u32 s61, s60, 16384
    s_lshl_b32 s62, s85, 7
    s_lshl_b32 s88, s88, 4
    s_add_u32 s62, s62, s88
    s_add_u32 s62, s62, 131072
    v_lshrrev_b32 v253, 3, v3
    v_lshlrev_b32 v252, 11, v253
    v_and_b32 v34, 7, v3
    v_lshl_add_u32 v252, v34, 4, v252
    v_lshlrev_b32 v253, 7, v253
    s_waitcnt vmcnt(5)
    buffer_load_dwordx4 v[148:151], v0, s[8:11], s81 offen offset:3072 nt
    v_and_b32 v244, 0xff, v68
    v_bfe_u32 v245, v68, 8, 8
    v_bfe_u32 v246, v68, 16, 8
    v_lshrrev_b32 v247, 24, v68
    v_bfe_u32 v254, v3, 3, 1
    v_lshlrev_b32 v254, 7, v254
    v_lshrrev_b32 v34, 4, v3
    v_lshl_add_u32 v254, v34, 5, v254
    s_lshl_b32 s63, s44, 10
    s_lshl_b32 s88, s2, 12
    s_add_u32 s63, s63, s88
    s_add_u32 s63, s63, 1310720
    v_lshrrev_b32 v255, 3, v3
    v_lshlrev_b32 v255, 12, v255
    v_and_b32 v34, 7, v3
    v_lshl_add_u32 v255, v34, 4, v255
    s_waitcnt vmcnt(5)
    buffer_load_dwordx4 v[152:155], v0, s[8:11], s80 offen offset:0 nt
    s_waitcnt vmcnt(5)
    buffer_load_dwordx4 v[156:159], v0, s[8:11], s80 offen offset:1024 nt
    s_waitcnt vmcnt(5)
    buffer_load_dwordx4 v[160:163], v0, s[8:11], s80 offen offset:2048 nt
    s_waitcnt vmcnt(5)
    buffer_load_dwordx4 v[164:167], v0, s[8:11], s80 offen offset:3072 nt
    s_waitcnt vmcnt(5)
    s_add_u32 s81, s81, 32768
    s_add_u32 s80, s80, 32768
    buffer_load_dwordx4 v[168:171], v0, s[8:11], s81 offen offset:0 nt
    s_waitcnt vmcnt(5)
    buffer_load_dwordx4 v[172:175], v0, s[8:11], s81 offen offset:1024 nt
    s_waitcnt vmcnt(5)
    buffer_load_dwordx4 v[176:179], v0, s[8:11], s81 offen offset:2048 nt
    s_waitcnt vmcnt(5)
    buffer_load_dwordx4 v[180:183], v0, s[8:11], s81 offen offset:3072 nt
    s_waitcnt vmcnt(5)
    buffer_load_dwordx4 v[184:187], v0, s[8:11], s80 offen offset:0 nt
    s_waitcnt vmcnt(5)
    buffer_load_dwordx4 v[188:191], v0, s[8:11], s80 offen offset:1024 nt
    buffer_load_dwordx4 v[12:15], v33, s[32:35], s86 offen sc1
    buffer_load_dwordx4 v[16:19], v33, s[32:35], s86 offen offset:16 sc1
    buffer_load_dwordx4 v[20:23], v33, s[32:35], s87 offen sc1
    buffer_load_dwordx4 v[24:27], v33, s[32:35], s87 offen offset:16 sc1
    s_waitcnt vmcnt(9)
    buffer_load_dwordx4 v[192:195], v0, s[8:11], s80 offen offset:2048 nt
    s_waitcnt vmcnt(9)
    buffer_load_dwordx4 v[196:199], v0, s[8:11], s80 offen offset:3072 nt
    s_waitcnt vmcnt(9)
    s_add_u32 s81, s81, 32768
    s_add_u32 s80, s80, 32768
    buffer_load_dwordx4 v[200:203], v0, s[8:11], s81 offen offset:0 nt
    s_waitcnt vmcnt(9)
    buffer_load_dwordx4 v[204:207], v0, s[8:11], s81 offen offset:1024 nt
    s_waitcnt vmcnt(9)
    buffer_load_dwordx4 v[208:211], v0, s[8:11], s81 offen offset:2048 nt
    s_waitcnt vmcnt(9)
    buffer_load_dwordx4 v[212:215], v0, s[8:11], s81 offen offset:3072 nt
    s_waitcnt vmcnt(11)
    buffer_load_dwordx4 v[216:219], v0, s[8:11], s80 offen offset:0 nt
    s_waitcnt vmcnt(11)
    buffer_load_dwordx4 v[220:223], v0, s[8:11], s80 offen offset:1024 nt
    s_waitcnt vmcnt(11)
    buffer_load_dwordx4 v[224:227], v0, s[8:11], s80 offen offset:2048 nt
    s_waitcnt vmcnt(11)
    buffer_load_dwordx4 v[228:231], v0, s[8:11], s80 offen offset:3072 nt
    v_mov_b32 v65, 1
    s_mov_b64 exec, 1
    ds_add_rtn_u32 v65, v64, v65
    s_mov_b64 exec, -1
    s_waitcnt vmcnt(10)
Lqchk_3:
    v_xor_b32 v35, v13, v68
    v_xor_b32 v34, v15, v68
    v_or_b32 v35, v35, v34
    v_xor_b32 v34, v17, v68
    v_or_b32 v35, v35, v34
    v_xor_b32 v34, v19, v68
    v_or_b32 v35, v35, v34
    v_xor_b32 v34, v21, v68
    v_or_b32 v35, v35, v34
    v_xor_b32 v34, v23, v68
    v_or_b32 v35, v35, v34
    v_xor_b32 v34, v25, v68
    v_or_b32 v35, v35, v34
    v_xor_b32 v34, v27, v68
    v_or_b32 v35, v35, v34
    v_cmp_ne_u32 vcc, 0, v35
    s_cbranch_vccz Lqok_4
    s_sub_u32 s84, s84, 1
    s_cbranch_scc1 L_end
    buffer_load_dwordx4 v[12:15], v33, s[32:35], s86 offen sc1
    buffer_load_dwordx4 v[16:19], v33, s[32:35], s86 offen offset:16 sc1
    buffer_load_dwordx4 v[20:23], v33, s[32:35], s87 offen sc1
    buffer_load_dwordx4 v[24:27], v33, s[32:35], s87 offen offset:16 sc1
    s_waitcnt vmcnt(0)
    s_branch Lqchk_3
Lqok_4:
    v_mov_b32 v8, v12
    v_mov_b32 v9, v14
    v_mov_b32 v10, v16
    v_mov_b32 v11, v18
    v_mov_b32 v4, v20
    v_mov_b32 v5, v22
    v_mov_b32 v6, v24
    v_mov_b32 v7, v26
    s_lshl_b32 s87, s20, 9
    v_add_u32 v70, s87, v71
    s_lshr_b32 s86, s20, 6
    s_cmp_lg_u32 s86, s56
    s_cbranch_scc1 Lsw_5
Lswr_6:
    s_nop 1
    v_mfma_f32_16x16x32_bf16 v[12:15], v[72:75], v[4:7], 0
    v_mfma_f32_16x16x32_bf16 v[16:19], v[76:79], v[4:7], 0
    v_mfma_f32_16x16x32_bf16 v[20:23], v[80:83], v[4:7], 0
    v_mfma_f32_16x16x32_bf16 v[24:27], v[84:87], v[4:7], 0
    s_nop 4
    v_mov_b32_dpp v36, v12 quad_perm:[0,0,0,0] row_mask:0xf bank_mask:0xf
    v_add_f32_dpp v36, v13, v36 quad_perm:[1,1,1,1] row_mask:0xf bank_mask:0xf
    v_add_f32_dpp v36, v14, v36 quad_perm:[2,2,2,2] row_mask:0xf bank_mask:0xf
    v_add_f32_dpp v36, v15, v36 quad_perm:[3,3,3,3] row_mask:0xf bank_mask:0xf
    v_mov_b32_dpp v37, v16 quad_perm:[0,0,0,0] row_mask:0xf bank_mask:0xf
    v_add_f32_dpp v37, v17, v37 quad_perm:[1,1,1,1] row_mask:0xf bank_mask:0xf
    v_add_f32_dpp v37, v18, v37 quad_perm:[2,2,2,2] row_mask:0xf bank_mask:0xf
    v_add_f32_dpp v37, v19, v37 quad_perm:[3,3,3,3] row_mask:0xf bank_mask:0xf
    v_mov_b32_dpp v38, v20 quad_perm:[0,0,0,0] row_mask:0xf bank_mask:0xf
    v_add_f32_dpp v38, v21, v38 quad_perm:[1,1,1,1] row_mask:0xf bank_mask:0xf
    v_add_f32_dpp v38, v22, v38 quad_perm:[2,2,2,2] row_mask:0xf bank_mask:0xf
    v_add_f32_dpp v38, v23, v38 quad_perm:[3,3,3,3] row_mask:0xf bank_mask:0xf
    v_mov_b32_dpp v39, v24 quad_perm:[0,0,0,0] row_mask:0xf bank_mask:0xf
    v_add_f32_dpp v39, v25, v39 quad_perm:[1,1,1,1] row_mask:0xf bank_mask:0xf
    v_add_f32_dpp v39, v26, v39 quad_perm:[2,2,2,2] row_mask:0xf bank_mask:0xf
    v_add_f32_dpp v39, v27, v39 quad_perm:[3,3,3,3] row_mask:0xf bank_mask:0xf
    s_mov_b64 exec, s[92:93]
    ds_write_b128 v70, v[36:39] offset:0
    s_mov_b64 exec, -1
    v_mfma_f32_16x16x32_bf16 v[12:15], v[88:91], v[4:7], 0
    v_mfma_f32_16x16x32_bf16 v[16:19], v[92:95], v[4:7], 0
    v_mfma_f32_16x16x32_bf16 v[20:23], v[96:99], v[4:7], 0
    v_mfma_f32_16x16x32_bf16 v[24:27], v[100:103], v[4:7], 0
    s_nop 4
    v_mov_b32_dpp v40, v12 quad_perm:[0,0,0,0] row_mask:0xf bank_mask:0xf
    v_add_f32_dpp v40, v13, v40 quad_perm:[1,1,1,1] row_mask:0xf bank_mask:0xf
    v_add_f32_dpp v40, v14, v40 quad_perm:[2,2,2,2] row_mask:0xf bank_mask:0xf
    v_add_f32_dpp v40, v15, v40 quad_perm:[3,3,3,3] row_mask:0xf bank_mask:0xf
    v_mov_b32_dpp v41, v16 quad_perm:[0,0,0,0] row_mask:0xf bank_mask:0xf
    v_add_f32_dpp v41, v17, v41 quad_perm:[1,1,1,1] row_mask:0xf bank_mask:0xf
    v_add_f32_dpp v41, v18, v41 quad_perm:[2,2,2,2] row_mask:0xf bank_mask:0xf
    v_add_f32_dpp v41, v19, v41 quad_perm:[3,3,3,3] row_mask:0xf bank_mask:0xf
    v_mov_b32_dpp v42, v20 quad_perm:[0,0,0,0] row_mask:0xf bank_mask:0xf
    v_add_f32_dpp v42, v21, v42 quad_perm:[1,1,1,1] row_mask:0xf bank_mask:0xf
    v_add_f32_dpp v42, v22, v42 quad_perm:[2,2,2,2] row_mask:0xf bank_mask:0xf
    v_add_f32_dpp v42, v23, v42 quad_perm:[3,3,3,3] row_mask:0xf bank_mask:0xf
    v_mov_b32_dpp v43, v24 quad_perm:[0,0,0,0] row_mask:0xf bank_mask:0xf
    v_add_f32_dpp v43, v25, v43 quad_perm:[1,1,1,1] row_mask:0xf bank_mask:0xf
    v_add_f32_dpp v43, v26, v43 quad_perm:[2,2,2,2] row_mask:0xf bank_mask:0xf
    v_add_f32_dpp v43, v27, v43 quad_perm:[3,3,3,3] row_mask:0xf bank_mask:0xf
    s_mov_b64 exec, s[92:93]
    ds_write_b128 v70, v[40:43] offset:256
    s_mov_b64 exec, -1
    s_add_u32 s78, s78, 1
    s_lshl_b32 s87, s21, 9
    v_add_u32 v70, s87, v71
    s_lshr_b32 s86, s21, 6
    s_cmp_lg_u32 s86, s56
    s_cbranch_scc1 Lsw_7
Lswr_8:
    s_nop 1
    v_mfma_f32_16x16x32_bf16 v[12:15], v[104:107], v[4:7], 0
    v_mfma_f32_16x16x32_bf16 v[16:19], v[108:111], v[4:7], 0
    v_mfma_f32_16x16x32_bf16 v[20:23], v[112:115], v[4:7], 0
    v_mfma_f32_16x16x32_bf16 v[24:27], v[116:119], v[4:7], 0
    s_nop 4
    v_mov_b32_dpp v36, v12 quad_perm:[0,0,0,0] row_mask:0xf bank_mask:0xf
    v_add_f32_dpp v36, v13, v36 quad_perm:[1,1,1,1] row_mask:0xf bank_mask:0xf
    v_add_f32_dpp v36, v14, v36 quad_perm:[2,2,2,2] row_mask:0xf bank_mask:0xf
    v_add_f32_dpp v36, v15, v36 quad_perm:[3,3,3,3] row_mask:0xf bank_mask:0xf
    v_mov_b32_dpp v37, v16 quad_perm:[0,0,0,0] row_mask:0xf bank_mask:0xf
    v_add_f32_dpp v37, v17, v37 quad_perm:[1,1,1,1] row_mask:0xf bank_mask:0xf
    v_add_f32_dpp v37, v18, v37 quad_perm:[2,2,2,2] row_mask:0xf bank_mask:0xf
    v_add_f32_dpp v37, v19, v37 quad_perm:[3,3,3,3] row_mask:0xf bank_mask:0xf
    v_mov_b32_dpp v38, v20 quad_perm:[0,0,0,0] row_mask:0xf bank_mask:0xf
    v_add_f32_dpp v38, v21, v38 quad_perm:[1,1,1,1] row_mask:0xf bank_mask:0xf
    v_add_f32_dpp v38, v22, v38 quad_perm:[2,2,2,2] row_mask:0xf bank_mask:0xf
    v_add_f32_dpp v38, v23, v38 quad_perm:[3,3,3,3] row_mask:0xf bank_mask:0xf
    v_mov_b32_dpp v39, v24 quad_perm:[0,0,0,0] row_mask:0xf bank_mask:0xf
    v_add_f32_dpp v39, v25, v39 quad_perm:[1,1,1,1] row_mask:0xf bank_mask:0xf
    v_add_f32_dpp v39, v26, v39 quad_perm:[2,2,2,2] row_mask:0xf bank_mask:0xf
    v_add_f32_dpp v39, v27, v39 quad_perm:[3,3,3,3] row_mask:0xf bank_mask:0xf
    s_mov_b64 exec, s[92:93]
    ds_write_b128 v70, v[36:39] offset:0
    s_mov_b64 exec, -1
    v_mfma_f32_16x16x32_bf16 v[12:15], v[120:123], v[4:7], 0
    v_mfma_f32_16x16x32_bf16 v[16:19], v[124:127], v[4:7], 0
    v_mfma_f32_16x16x32_bf16 v[20:23], v[128:131], v[4:7], 0
    v_mfma_f32_16x16x32_bf16 v[24:27], v[132:135], v[4:7], 0
    s_nop 4
    v_mov_b32_dpp v40, v12 quad_perm:[0,0,0,0] row_mask:0xf bank_mask:0xf
    v_add_f32_dpp v40, v13, v40 quad_perm:[1,1,1,1] row_mask:0xf bank_mask:0xf
    v_add_f32_dpp v40, v14, v40 quad_perm:[2,2,2,2] row_mask:0xf bank_mask:0xf
    v_add_f32_dpp v40, v15, v40 quad_perm:[3,3,3,3] row_mask:0xf bank_mask:0xf
    v_mov_b32_dpp v41, v16 quad_perm:[0,0,0,0] row_mask:0xf bank_mask:0xf
    v_add_f32_dpp v41, v17, v41 quad_perm:[1,1,1,1] row_mask:0xf bank_mask:0xf
    v_add_f32_dpp v41, v18, v41 quad_perm:[2,2,2,2] row_mask:0xf bank_mask:0xf
    v_add_f32_dpp v41, v19, v41 quad_perm:[3,3,3,3] row_mask:0xf bank_mask:0xf
    v_mov_b32_dpp v42, v20 quad_perm:[0,0,0,0] row_mask:0xf bank_mask:0xf
    v_add_f32_dpp v42, v21, v42 quad_perm:[1,1,1,1] row_mask:0xf bank_mask:0xf
    v_add_f32_dpp v42, v22, v42 quad_perm:[2,2,2,2] row_mask:0xf bank_mask:0xf
    v_add_f32_dpp v42, v23, v42 quad_perm:[3,3,3,3] row_mask:0xf bank_mask:0xf
    v_mov_b32_dpp v43, v24 quad_perm:[0,0,0,0] row_mask:0xf bank_mask:0xf
    v_add_f32_dpp v43, v25, v43 quad_perm:[1,1,1,1] row_mask:0xf bank_mask:0xf
    v_add_f32_dpp v43, v26, v43 quad_perm:[2,2,2,2] row_mask:0xf bank_mask:0xf
    v_add_f32_dpp v43, v27, v43 quad_perm:[3,3,3,3] row_mask:0xf bank_mask:0xf
    s_mov_b64 exec, s[92:93]
    ds_write_b128 v70, v[40:43] offset:256
    s_mov_b64 exec, -1
    s_add_u32 s78, s78, 1
    s_lshl_b32 s87, s22, 9
    v_add_u32 v70, s87, v71
    s_lshr_b32 s86, s22, 6
    s_cmp_lg_u32 s86, s56
    s_cbranch_scc1 Lsw_9
Lswr_10:
    s_nop 1
    v_mfma_f32_16x16x32_bf16 v[12:15], v[136:139], v[4:7], 0
    v_mfma_f32_16x16x32_bf16 v[16:19], v[140:143], v[4:7], 0
    v_mfma_f32_16x16x32_bf16 v[20:23], v[144:147], v[4:7], 0
    v_mfma_f32_16x16x32_bf16 v[24:27], v[148:151], v[4:7], 0
    s_nop 4
    v_mov_b32_dpp v36, v12 quad_perm:[0,0,0,0] row_mask:0xf bank_mask:0xf
    v_add_f32_dpp v36, v13, v36 quad_perm:[1,1,1,1] row_mask:0xf bank_mask:0xf
    v_add_f32_dpp v36, v14, v36 quad_perm:[2,2,2,2] row_mask:0xf bank_mask:0xf
    v_add_f32_dpp v36, v15, v36 quad_perm:[3,3,3,3] row_mask:0xf bank_mask:0xf
    v_mov_b32_dpp v37, v16 quad_perm:[0,0,0,0] row_mask:0xf bank_mask:0xf
    v_add_f32_dpp v37, v17, v37 quad_perm:[1,1,1,1] row_mask:0xf bank_mask:0xf
    v_add_f32_dpp v37, v18, v37 quad_perm:[2,2,2,2] row_mask:0xf bank_mask:0xf
    v_add_f32_dpp v37, v19, v37 quad_perm:[3,3,3,3] row_mask:0xf bank_mask:0xf
    v_mov_b32_dpp v38, v20 quad_perm:[0,0,0,0] row_mask:0xf bank_mask:0xf
    v_add_f32_dpp v38, v21, v38 quad_perm:[1,1,1,1] row_mask:0xf bank_mask:0xf
    v_add_f32_dpp v38, v22, v38 quad_perm:[2,2,2,2] row_mask:0xf bank_mask:0xf
    v_add_f32_dpp v38, v23, v38 quad_perm:[3,3,3,3] row_mask:0xf bank_mask:0xf
    v_mov_b32_dpp v39, v24 quad_perm:[0,0,0,0] row_mask:0xf bank_mask:0xf
    v_add_f32_dpp v39, v25, v39 quad_perm:[1,1,1,1] row_mask:0xf bank_mask:0xf
    v_add_f32_dpp v39, v26, v39 quad_perm:[2,2,2,2] row_mask:0xf bank_mask:0xf
    v_add_f32_dpp v39, v27, v39 quad_perm:[3,3,3,3] row_mask:0xf bank_mask:0xf
    s_mov_b64 exec, s[92:93]
    ds_write_b128 v70, v[36:39] offset:0
    s_mov_b64 exec, -1
    v_mfma_f32_16x16x32_bf16 v[12:15], v[152:155], v[4:7], 0
    v_mfma_f32_16x16x32_bf16 v[16:19], v[156:159], v[4:7], 0
    v_mfma_f32_16x16x32_bf16 v[20:23], v[160:163], v[4:7], 0
    v_mfma_f32_16x16x32_bf16 v[24:27], v[164:167], v[4:7], 0
    s_nop 4
    v_mov_b32_dpp v40, v12 quad_perm:[0,0,0,0] row_mask:0xf bank_mask:0xf
    v_add_f32_dpp v40, v13, v40 quad_perm:[1,1,1,1] row_mask:0xf bank_mask:0xf
    v_add_f32_dpp v40, v14, v40 quad_perm:[2,2,2,2] row_mask:0xf bank_mask:0xf
    v_add_f32_dpp v40, v15, v40 quad_perm:[3,3,3,3] row_mask:0xf bank_mask:0xf
    v_mov_b32_dpp v41, v16 quad_perm:[0,0,0,0] row_mask:0xf bank_mask:0xf
    v_add_f32_dpp v41, v17, v41 quad_perm:[1,1,1,1] row_mask:0xf bank_mask:0xf
    v_add_f32_dpp v41, v18, v41 quad_perm:[2,2,2,2] row_mask:0xf bank_mask:0xf
    v_add_f32_dpp v41, v19, v41 quad_perm:[3,3,3,3] row_mask:0xf bank_mask:0xf
    v_mov_b32_dpp v42, v20 quad_perm:[0,0,0,0] row_mask:0xf bank_mask:0xf
    v_add_f32_dpp v42, v21, v42 quad_perm:[1,1,1,1] row_mask:0xf bank_mask:0xf
    v_add_f32_dpp v42, v22, v42 quad_perm:[2,2,2,2] row_mask:0xf bank_mask:0xf
    v_add_f32_dpp v42, v23, v42 quad_perm:[3,3,3,3] row_mask:0xf bank_mask:0xf
    v_mov_b32_dpp v43, v24 quad_perm:[0,0,0,0] row_mask:0xf bank_mask:0xf
    v_add_f32_dpp v43, v25, v43 quad_perm:[1,1,1,1] row_mask:0xf bank_mask:0xf
    v_add_f32_dpp v43, v26, v43 quad_perm:[2,2,2,2] row_mask:0xf bank_mask:0xf
    v_add_f32_dpp v43, v27, v43 quad_perm:[3,3,3,3] row_mask:0xf bank_mask:0xf
    s_mov_b64 exec, s[92:93]
    ds_write_b128 v70, v[40:43] offset:256
    s_mov_b64 exec, -1
    s_add_u32 s78, s78, 1
    .p2align 6
L_kloop:
    s_waitcnt lgkmcnt(0)
    v_readfirstlane_b32 s82, v65
    s_cmp_ge_u32 s23, 72
    s_cbranch_scc1 L_v0_3
    s_lshl_b32 s87, s23, 9
    v_add_u32 v70, s87, v71
    s_lshr_b32 s86, s23, 6
    s_cmp_lg_u32 s86, s56
    s_cbranch_scc1 Lsw_13
Lswr_14:
    s_cmp_ge_u32 s82, s58
    s_cbranch_scc1 Ltov_11
Ltovr_12:
    s_sub_u32 s88, s82, s59
    s_sub_u32 s86, s88, s66
    s_cselect_b32 s87, 0, 8
    s_sub_u32 s87, s88, s87
    s_cmp_lt_u32 s86, 8
    s_cselect_b32 s86, s86, s87
    s_cselect_b32 s87, s65, s64
    s_cselect_b32 s88, 64, 0
    s_cselect_b64 s[8:9], s[14:15], s[12:13]
    s_add_u32 s88, s88, s59
    s_add_u32 s22, s88, s86
    s_lshr_b32 s88, s86, 2
    s_lshl_b32 s88, s88, 15
    s_and_b32 s86, s86, 3
    s_lshl_b32 s86, s86, 12
    s_add_u32 s87, s87, s88
    s_add_u32 s81, s87, s86
    s_add_u32 s80, s81, 16384
    s_waitcnt vmcnt(5)
    buffer_load_dwordx4 v[136:139], v0, s[8:11], s81 offen offset:0 nt
    v_mfma_f32_16x16x32_bf16 v[12:15], v[168:171], v[4:7], 0
    v_mfma_f32_16x16x32_bf16 v[16:19], v[172:175], v[4:7], 0
    v_mfma_f32_16x16x32_bf16 v[20:23], v[176:179], v[4:7], 0
    v_mfma_f32_16x16x32_bf16 v[24:27], v[180:183], v[4:7], 0
    s_waitcnt vmcnt(4)
    buffer_load_dwordx4 v[140:143], v0, s[8:11], s81 offen offset:1024 nt
    s_nop 2
    v_mov_b32_dpp v36, v12 quad_perm:[0,0,0,0] row_mask:0xf bank_mask:0xf
    v_add_f32_dpp v36, v13, v36 quad_perm:[1,1,1,1] row_mask:0xf bank_mask:0xf
    v_add_f32_dpp v36, v14, v36 quad_perm:[2,2,2,2] row_mask:0xf bank_mask:0xf
    v_add_f32_dpp v36, v15, v36 quad_perm:[3,3,3,3] row_mask:0xf bank_mask:0xf
    s_waitcnt vmcnt(4)
    buffer_load_dwordx4 v[144:147], v0, s[8:11], s81 offen offset:2048 nt
    v_mov_b32_dpp v37, v16 quad_perm:[0,0,0,0] row_mask:0xf bank_mask:0xf
    v_add_f32_dpp v37, v17, v37 quad_perm:[1,1,1,1] row_mask:0xf bank_mask:0xf
    v_add_f32_dpp v37, v18, v37 quad_perm:[2,2,2,2] row_mask:0xf bank_mask:0xf
    v_add_f32_dpp v37, v19, v37 quad_perm:[3,3,3,3] row_mask:0xf bank_mask:0xf
    v_mov_b32_dpp v38, v20 quad_perm:[0,0,0,0] row_mask:0xf bank_mask:0xf
    v_add_f32_dpp v38, v21, v38 quad_perm:[1,1,1,1] row_mask:0xf bank_mask:0xf
    v_add_f32_dpp v38, v22, v38 quad_perm:[2,2,2,2] row_mask:0xf bank_mask:0xf
    v_add_f32_dpp v38, v23, v38 quad_perm:[3,3,3,3] row_mask:0xf bank_mask:0xf
    s_waitcnt vmcnt(4)
    buffer_load_dwordx4 v[148:151], v0, s[8:11], s81 offen offset:3072 nt
    v_mov_b32_dpp v39, v24 quad_perm:[0,0,0,0] row_mask:0xf bank_mask:0xf
    v_add_f32_dpp v39, v25, v39 quad_perm:[1,1,1,1] row_mask:0xf bank_mask:0xf
    v_add_f32_dpp v39, v26, v39 quad_perm:[2,2,2,2] row_mask:0xf bank_mask:0xf
    v_add_f32_dpp v39, v27, v39 quad_perm:[3,3,3,3] row_mask:0xf bank_mask:0xf
    s_mov_b64 exec, s[92:93]
    ds_write_b128 v70, v[36:39] offset:0
    s_mov_b64 exec, -1
    s_waitcnt vmcnt(4)
    buffer_load_dwordx4 v[152:155], v0, s[8:11], s80 offen offset:0 nt
    v_mfma_f32_16x16x32_bf16 v[12:15], v[184:187], v[4:7], 0
    v_mfma_f32_16x16x32_bf16 v[16:19], v[188:191], v[4:7], 0
    v_mfma_f32_16x16x32_bf16 v[20:23], v[192:195], v[4:7], 0
    v_mfma_f32_16x16x32_bf16 v[24:27], v[196:199], v[4:7], 0
    s_waitcnt vmcnt(4)
    buffer_load_dwordx4 v[156:159], v0, s[8:11], s80 offen offset:1024 nt
    s_nop 2
    v_mov_b32_dpp v40, v12 quad_perm:[0,0,0,0] row_mask:0xf bank_mask:0xf
    v_add_f32_dpp v40, v13, v40 quad_perm:[1,1,1,1] row_mask:0xf bank_mask:0xf
    v_add_f32_dpp v40, v14, v40 quad_perm:[2,2,2,2] row_mask:0xf bank_mask:0xf
    v_add_f32_dpp v40, v15, v40 quad_perm:[3,3,3,3] row_mask:0xf bank_mask:0xf
    s_waitcnt vmcnt(4)
    buffer_load_dwordx4 v[160:163], v0, s[8:11], s80 offen offset:2048 nt
    v_mov_b32_dpp v41, v16 quad_perm:[0,0,0,0] row_mask:0xf bank_mask:0xf
    v_add_f32_dpp v41, v17, v41 quad_perm:[1,1,1,1] row_mask:0xf bank_mask:0xf
    v_add_f32_dpp v41, v18, v41 quad_perm:[2,2,2,2] row_mask:0xf bank_mask:0xf
    v_add_f32_dpp v41, v19, v41 quad_perm:[3,3,3,3] row_mask:0xf bank_mask:0xf
    v_mov_b32_dpp v42, v20 quad_perm:[0,0,0,0] row_mask:0xf bank_mask:0xf
    v_add_f32_dpp v42, v21, v42 quad_perm:[1,1,1,1] row_mask:0xf bank_mask:0xf
    v_add_f32_dpp v42, v22, v42 quad_perm:[2,2,2,2] row_mask:0xf bank_mask:0xf
    v_add_f32_dpp v42, v23, v42 quad_perm:[3,3,3,3] row_mask:0xf bank_mask:0xf
    s_waitcnt vmcnt(4)
    v_mov_b32 v65, 1
    s_mov_b64 exec, 1
    ds_add_rtn_u32 v65, v64, v65
    s_mov_b64 exec, -1
    buffer_load_dwordx4 v[164:167], v0, s[8:11], s80 offen offset:3072 nt
    v_mov_b32_dpp v43, v24 quad_perm:[0,0,0,0] row_mask:0xf bank_mask:0xf
    v_add_f32_dpp v43, v25, v43 quad_perm:[1,1,1,1] row_mask:0xf bank_mask:0xf
    v_add_f32_dpp v43, v26, v43 quad_perm:[2,2,2,2] row_mask:0xf bank_mask:0xf
    v_add_f32_dpp v43, v27, v43 quad_perm:[3,3,3,3] row_mask:0xf bank_mask:0xf
    s_mov_b64 exec, s[92:93]
    ds_write_b128 v70, v[40:43] offset:256
    s_mov_b64 exec, -1
    s_add_u32 s78, s78, 1
    s_waitcnt lgkmcnt(0)
    v_readfirstlane_b32 s82, v65
    s_cmp_ge_u32 s24, 72
    s_cbranch_scc1 L_v0_4
    s_lshl_b32 s87, s24, 9
    v_add_u32 v70, s87, v71
    s_lshr_b32 s86, s24, 6
    s_cmp_lg_u32 s86, s56
    s_cbranch_scc1 Lsw_17
Lswr_18:
    s_cmp_ge_u32 s82, s58
    s_cbranch_scc1 Ltov_15
Ltovr_16:
    s_sub_u32 s88, s82, s59
    s_sub_u32 s86, s88, s66
    s_cselect_b32 s87, 0, 8
    s_sub_u32 s87, s88, s87
    s_cmp_lt_u32 s86, 8
    s_cselect_b32 s86, s86, s87
    s_cselect_b32 s87, s65, s64
    s_cselect_b32 s88, 64, 0
    s_cselect_b64 s[8:9], s[14:15], s[12:13]
    s_add_u32 s88, s88, s59
    s_add_u32 s23, s88, s86
    s_lshr_b32 s88, s86, 2
    s_lshl_b32 s88, s88, 15
    s_and_b32 s86, s86, 3
    s_lshl_b32 s86, s86, 12
    s_add_u32 s87, s87, s88
    s_add_u32 s81, s87, s86
    s_add_u32 s80, s81, 16384
    s_waitcnt vmcnt(5)
    buffer_load_dwordx4 v[168:171], v0, s[8:11], s81 offen offset:0 nt
    v_mfma_f32_16x16x32_bf16 v[12:15], v[200:203], v[4:7], 0
    v_mfma_f32_16x16x32_bf16 v[16:19], v[204:207], v[4:7], 0
    v_mfma_f32_16x16x32_bf16 v[20:23], v[208:211], v[4:7], 0
    v_mfma_f32_16x16x32_bf16 v[24:27], v[212:215], v[4:7], 0
    s_waitcnt vmcnt(4)
    buffer_load_dwordx4 v[172:175], v0, s[8:11], s81 offen offset:1024 nt
    s_nop 2
    v_mov_b32_dpp v36, v12 quad_perm:[0,0,0,0] row_mask:0xf bank_mask:0xf
    v_add_f32_dpp v36, v13, v36 quad_perm:[1,1,1,1] row_mask:0xf bank_mask:0xf
    v_add_f32_dpp v36, v14, v36 quad_perm:[2,2,2,2] row_mask:0xf bank_mask:0xf
    v_add_f32_dpp v36, v15, v36 quad_perm:[3,3,3,3] row_mask:0xf bank_mask:0xf
    s_waitcnt vmcnt(4)
    buffer_load_dwordx4 v[176:179], v0, s[8:11], s81 offen offset:2048 nt
    v_mov_b32_dpp v37, v16 quad_perm:[0,0,0,0] row_mask:0xf bank_mask:0xf
    v_add_f32_dpp v37, v17, v37 quad_perm:[1,1,1,1] row_mask:0xf bank_mask:0xf
    v_add_f32_dpp v37, v18, v37 quad_perm:[2,2,2,2] row_mask:0xf bank_mask:0xf
    v_add_f32_dpp v37, v19, v37 quad_perm:[3,3,3,3] row_mask:0xf bank_mask:0xf
    v_mov_b32_dpp v38, v20 quad_perm:[0,0,0,0] row_mask:0xf bank_mask:0xf
    v_add_f32_dpp v38, v21, v38 quad_perm:[1,1,1,1] row_mask:0xf bank_mask:0xf
    v_add_f32_dpp v38, v22, v38 quad_perm:[2,2,2,2] row_mask:0xf bank_mask:0xf
    v_add_f32_dpp v38, v23, v38 quad_perm:[3,3,3,3] row_mask:0xf bank_mask:0xf
    s_waitcnt vmcnt(4)
    buffer_load_dwordx4 v[180:183], v0, s[8:11], s81 offen offset:3072 nt
    v_mov_b32_dpp v39, v24 quad_perm:[0,0,0,0] row_mask:0xf bank_mask:0xf
    v_add_f32_dpp v39, v25, v39 quad_perm:[1,1,1,1] row_mask:0xf bank_mask:0xf
    v_add_f32_dpp v39, v26, v39 quad_perm:[2,2,2,2] row_mask:0xf bank_mask:0xf
    v_add_f32_dpp v39, v27, v39 quad_perm:[3,3,3,3] row_mask:0xf bank_mask:0xf
    s_mov_b64 exec, s[92:93]
    ds_write_b128 v70, v[36:39] offset:0
    s_mov_b64 exec, -1
    s_waitcnt vmcnt(4)
    buffer_load_dwordx4 v[184:187], v0, s[8:11], s80 offen offset:0 nt
    v_mfma_f32_16x16x32_bf16 v[12:15], v[216:219], v[4:7], 0
    v_mfma_f32_16x16x32_bf16 v[16:19], v[220:223], v[4:7], 0
    v_mfma_f32_16x16x32_bf16 v[20:23], v[224:227], v[4:7], 0
    v_mfma_f32_16x16x32_bf16 v[24:27], v[228:231], v[4:7], 0
    s_waitcnt vmcnt(4)
    buffer_load_dwordx4 v[188:191], v0, s[8:11], s80 offen offset:1024 nt
    s_nop 2
    v_mov_b32_dpp v40, v12 quad_perm:[0,0,0,0] row_mask:0xf bank_mask:0xf
    v_add_f32_dpp v40, v13, v40 quad_perm:[1,1,1,1] row_mask:0xf bank_mask:0xf
    v_add_f32_dpp v40, v14, v40 quad_perm:[2,2,2,2] row_mask:0xf bank_mask:0xf
    v_add_f32_dpp v40, v15, v40 quad_perm:[3,3,3,3] row_mask:0xf bank_mask:0xf
    s_waitcnt vmcnt(4)
    buffer_load_dwordx4 v[192:195], v0, s[8:11], s80 offen offset:2048 nt
    v_mov_b32_dpp v41, v16 quad_perm:[0,0,0,0] row_mask:0xf bank_mask:0xf
    v_add_f32_dpp v41, v17, v41 quad_perm:[1,1,1,1] row_mask:0xf bank_mask:0xf
    v_add_f32_dpp v41, v18, v41 quad_perm:[2,2,2,2] row_mask:0xf bank_mask:0xf
    v_add_f32_dpp v41, v19, v41 quad_perm:[3,3,3,3] row_mask:0xf bank_mask:0xf
    v_mov_b32_dpp v42, v20 quad_perm:[0,0,0,0] row_mask:0xf bank_mask:0xf
    v_add_f32_dpp v42, v21, v42 quad_perm:[1,1,1,1] row_mask:0xf bank_mask:0xf
    v_add_f32_dpp v42, v22, v42 quad_perm:[2,2,2,2] row_mask:0xf bank_mask:0xf
    v_add_f32_dpp v42, v23, v42 quad_perm:[3,3,3,3] row_mask:0xf bank_mask:0xf
    s_waitcnt vmcnt(4)
    v_mov_b32 v65, 1
    s_mov_b64 exec, 1
    ds_add_rtn_u32 v65, v64, v65
    s_mov_b64 exec, -1
    buffer_load_dwordx4 v[196:199], v0, s[8:11], s80 offen offset:3072 nt
    v_mov_b32_dpp v43, v24 quad_perm:[0,0,0,0] row_mask:0xf bank_mask:0xf
    v_add_f32_dpp v43, v25, v43 quad_perm:[1,1,1,1] row_mask:0xf bank_mask:0xf
    v_add_f32_dpp v43, v26, v43 quad_perm:[2,2,2,2] row_mask:0xf bank_mask:0xf
    v_add_f32_dpp v43, v27, v43 quad_perm:[3,3,3,3] row_mask:0xf bank_mask:0xf
    s_mov_b64 exec, s[92:93]
    ds_write_b128 v70, v[40:43] offset:256
    s_mov_b64 exec, -1
    s_add_u32 s78, s78, 1
    s_waitcnt lgkmcnt(0)
    v_readfirstlane_b32 s82, v65
    s_cmp_ge_u32 s22, 72
    s_cbranch_scc1 L_v0_2
    s_lshl_b32 s87, s22, 9
    v_add_u32 v70, s87, v71
    s_lshr_b32 s86, s22, 6
    s_cmp_lg_u32 s86, s56
    s_cbranch_scc1 Lsw_21
Lswr_22:
    s_cmp_ge_u32 s82, s58
    s_cbranch_scc1 Ltov_19
Ltovr_20:
    s_sub_u32 s88, s82, s59
    s_sub_u32 s86, s88, s66
    s_cselect_b32 s87, 0, 8
    s_sub_u32 s87, s88, s87
    s_cmp_lt_u32 s86, 8
    s_cselect_b32 s86, s86, s87
    s_cselect_b32 s87, s65, s64
    s_cselect_b32 s88, 64, 0
    s_cselect_b64 s[8:9], s[14:15], s[12:13]
    s_add_u32 s88, s88, s59
    s_add_u32 s24, s88, s86
    s_lshr_b32 s88, s86, 2
    s_lshl_b32 s88, s88, 15
    s_and_b32 s86, s86, 3
    s_lshl_b32 s86, s86, 12
    s_add_u32 s87, s87, s88
    s_add_u32 s81, s87, s86
    s_add_u32 s80, s81, 16384
    s_waitcnt vmcnt(5)
    buffer_load_dwordx4 v[200:203], v0, s[8:11], s81 offen offset:0 nt
    v_mfma_f32_16x16x32_bf16 v[12:15], v[136:139], v[4:7], 0
    v_mfma_f32_16x16x32_bf16 v[16:19], v[140:143], v[4:7], 0
    v_mfma_f32_16x16x32_bf16 v[20:23], v[144:147], v[4:7], 0
    v_mfma_f32_16x16x32_bf16 v[24:27], v[148:151], v[4:7], 0
    s_waitcnt vmcnt(4)
    buffer_load_dwordx4 v[204:207], v0, s[8:11], s81 offen offset:1024 nt
    s_nop 2
    v_mov_b32_dpp v36, v12 quad_perm:[0,0,0,0] row_mask:0xf bank_mask:0xf
    v_add_f32_dpp v36, v13, v36 quad_perm:[1,1,1,1] row_mask:0xf bank_mask:0xf
    v_add_f32_dpp v36, v14, v36 quad_perm:[2,2,2,2] row_mask:0xf bank_mask:0xf
    v_add_f32_dpp v36, v15, v36 quad_perm:[3,3,3,3] row_mask:0xf bank_mask:0xf
    s_waitcnt vmcnt(4)
    buffer_load_dwordx4 v[208:211], v0, s[8:11], s81 offen offset:2048 nt
    v_mov_b32_dpp v37, v16 quad_perm:[0,0,0,0] row_mask:0xf bank_mask:0xf
    v_add_f32_dpp v37, v17, v37 quad_perm:[1,1,1,1] row_mask:0xf bank_mask:0xf
    v_add_f32_dpp v37, v18, v37 quad_perm:[2,2,2,2] row_mask:0xf bank_mask:0xf
    v_add_f32_dpp v37, v19, v37 quad_perm:[3,3,3,3] row_mask:0xf bank_mask:0xf
    v_mov_b32_dpp v38, v20 quad_perm:[0,0,0,0] row_mask:0xf bank_mask:0xf
    v_add_f32_dpp v38, v21, v38 quad_perm:[1,1,1,1] row_mask:0xf bank_mask:0xf
    v_add_f32_dpp v38, v22, v38 quad_perm:[2,2,2,2] row_mask:0xf bank_mask:0xf
    v_add_f32_dpp v38, v23, v38 quad_perm:[3,3,3,3] row_mask:0xf bank_mask:0xf
    s_waitcnt vmcnt(4)
    buffer_load_dwordx4 v[212:215], v0, s[8:11], s81 offen offset:3072 nt
    v_mov_b32_dpp v39, v24 quad_perm:[0,0,0,0] row_mask:0xf bank_mask:0xf
    v_add_f32_dpp v39, v25, v39 quad_perm:[1,1,1,1] row_mask:0xf bank_mask:0xf
    v_add_f32_dpp v39, v26, v39 quad_perm:[2,2,2,2] row_mask:0xf bank_mask:0xf
    v_add_f32_dpp v39, v27, v39 quad_perm:[3,3,3,3] row_mask:0xf bank_mask:0xf
    s_mov_b64 exec, s[92:93]
    ds_write_b128 v70, v[36:39] offset:0
    s_mov_b64 exec, -1
    s_waitcnt vmcnt(4)
    buffer_load_dwordx4 v[216:219], v0, s[8:11], s80 offen offset:0 nt
    v_mfma_f32_16x16x32_bf16 v[12:15], v[152:155], v[4:7], 0
    v_mfma_f32_16x16x32_bf16 v[16:19], v[156:159], v[4:7], 0
    v_mfma_f32_16x16x32_bf16 v[20:23], v[160:163], v[4:7], 0
    v_mfma_f32_16x16x32_bf16 v[24:27], v[164:167], v[4:7], 0
    s_waitcnt vmcnt(4)
    buffer_load_dwordx4 v[220:223], v0, s[8:11], s80 offen offset:1024 nt
    s_nop 2
    v_mov_b32_dpp v40, v12 quad_perm:[0,0,0,0] row_mask:0xf bank_mask:0xf
    v_add_f32_dpp v40, v13, v40 quad_perm:[1,1,1,1] row_mask:0xf bank_mask:0xf
    v_add_f32_dpp v40, v14, v40 quad_perm:[2,2,2,2] row_mask:0xf bank_mask:0xf
    v_add_f32_dpp v40, v15, v40 quad_perm:[3,3,3,3] row_mask:0xf bank_mask:0xf
    s_waitcnt vmcnt(4)
    buffer_load_dwordx4 v[224:227], v0, s[8:11], s80 offen offset:2048 nt
    v_mov_b32_dpp v41, v16 quad_perm:[0,0,0,0] row_mask:0xf bank_mask:0xf
    v_add_f32_dpp v41, v17, v41 quad_perm:[1,1,1,1] row_mask:0xf bank_mask:0xf
    v_add_f32_dpp v41, v18, v41 quad_perm:[2,2,2,2] row_mask:0xf bank_mask:0xf
    v_add_f32_dpp v41, v19, v41 quad_perm:[3,3,3,3] row_mask:0xf bank_mask:0xf
    v_mov_b32_dpp v42, v20 quad_perm:[0,0,0,0] row_mask:0xf bank_mask:0xf
    v_add_f32_dpp v42, v21, v42 quad_perm:[1,1,1,1] row_mask:0xf bank_mask:0xf
    v_add_f32_dpp v42, v22, v42 quad_perm:[2,2,2,2] row_mask:0xf bank_mask:0xf
    v_add_f32_dpp v42, v23, v42 quad_perm:[3,3,3,3] row_mask:0xf bank_mask:0xf
    s_waitcnt vmcnt(4)
    v_mov_b32 v65, 1
    s_mov_b64 exec, 1
    ds_add_rtn_u32 v65, v64, v65
    s_mov_b64 exec, -1
    buffer_load_dwordx4 v[228:231], v0, s[8:11], s80 offen offset:3072 nt
    v_mov_b32_dpp v43, v24 quad_perm:[0,0,0,0] row_mask:0xf bank_mask:0xf
    v_add_f32_dpp v43, v25, v43 quad_perm:[1,1,1,1] row_mask:0xf bank_mask:0xf
    v_add_f32_dpp v43, v26, v43 quad_perm:[2,2,2,2] row_mask:0xf bank_mask:0xf
    v_add_f32_dpp v43, v27, v43 quad_perm:[3,3,3,3] row_mask:0xf bank_mask:0xf
    s_mov_b64 exec, s[92:93]
    ds_write_b128 v70, v[40:43] offset:256
    s_mov_b64 exec, -1
    s_add_u32 s78, s78, 1
    s_branch L_kloop
L_v0_3:
    s_mov_b32 s56, 0
    s_branch L_vina3
L_v0_4:
    s_mov_b32 s56, 0
    s_branch L_vina4
L_v0_2:
    s_mov_b32 s56, 0
    s_branch L_vina2
L_vloopa:
    s_waitcnt lgkmcnt(0)
    v_readfirstlane_b32 s82, v65
L_vina3:
    s_sub_u32 s86, s23, 72
    s_lshl_b32 s87, s86, 9
    v_add_u32 v70, s87, v71
    s_lshr_b32 s86, s86, 6
    s_cmp_lg_u32 s86, s56
    s_cbranch_scc1 Lsw_23
Lswr_24:
    ds_read_b128 v[12:15], v70 offset:0
    ds_read_b128 v[16:19], v70 offset:256
    s_cmp_ge_u32 s82, 144
    s_cbranch_scc1 L_fdrain3
    s_sub_u32 s88, s82, s59
    s_sub_u32 s86, s88, s66
    s_cselect_b32 s87, 0, 8
    s_sub_u32 s87, s88, s87
    s_cmp_lt_u32 s86, 8
    s_cselect_b32 s86, s86, s87
    s_cselect_b32 s87, s65, s64
    s_cselect_b32 s88, 64, 0
    s_cselect_b64 s[8:9], s[14:15], s[12:13]
    s_add_u32 s88, s88, s59
    s_add_u32 s22, s88, s86
    s_lshr_b32 s88, s86, 2
    s_lshl_b32 s88, s88, 15
    s_and_b32 s86, s86, 3
    s_lshl_b32 s86, s86, 12
    s_add_u32 s87, s87, s88
    s_add_u32 s81, s87, s86
    s_add_u32 s80, s81, 16384
L_vgoa3:
    s_waitcnt vmcnt(5)
    buffer_load_dwordx4 v[136:139], v0, s[8:11], s81 offen offset:0 nt
    s_waitcnt lgkmcnt(0)
Lnrb_26:
    v_max3_f32 v33, v12, v13, v14
    v_cmp_eq_u32 vcc, 0x7fc0dead, v15
    v_max3_f32 v33, v33, v15, v16
    s_cbranch_vccnz Lnr_25
    v_cmp_eq_u32 vcc, 0x7fc0dead, v19
    v_max3_f32 v33, v33, v17, v18
    s_cbranch_vccnz Lnr_25
    v_max_f32 v33, v33, v19
    v_cmp_gt_f32 vcc, v33, v28
    s_cbranch_vccnz Lrs_27
Lrsb_28:
    v_fma_f32 v40, v12, s77, -v30
    v_fma_f32 v41, v13, s77, -v30
    v_fma_f32 v42, v14, s77, -v30
    v_fma_f32 v43, v15, s77, -v30
    s_waitcnt vmcnt(4)
    buffer_load_dwordx4 v[140:143], v0, s[8:11], s81 offen offset:1024 nt
    v_exp_f32 v40, v40
    v_exp_f32 v41, v41
    v_exp_f32 v42, v42
    v_exp_f32 v43, v43
    v_cvt_pk_bf16_f32 v44, v40, v40
    v_cvt_pk_bf16_f32 v45, v41, v41
    v_cvt_pk_bf16_f32 v46, v42, v42
    v_cvt_pk_bf16_f32 v47, v43, v43
    s_waitcnt vmcnt(4)
    buffer_load_dwordx4 v[144:147], v0, s[8:11], s81 offen offset:2048 nt
    v_and_b32 v48, v44, v31
    v_and_b32 v49, v44, v32
    v_and_b32 v50, v45, v31
    v_and_b32 v51, v45, v32
    v_and_b32 v52, v46, v31
    v_and_b32 v53, v46, v32
    v_and_b32 v54, v47, v31
    v_and_b32 v55, v47, v32
    v_add_f32 v33, v40, v41
    v_add_f32 v34, v42, v43
    s_waitcnt vmcnt(4)
    buffer_load_dwordx4 v[148:151], v0, s[8:11], s81 offen offset:3072 nt
    v_mfma_f32_16x16x16_bf16 v[56:59], v[168:169], v[48:49], v[56:59]
    v_mfma_f32_16x16x16_bf16 v[60:63], v[170:171], v[48:49], v[60:63]
    v_add_f32 v29, v29, v33
    v_mfma_f32_16x16x16_bf16 v[56:59], v[172:173], v[50:51], v[56:59]
    v_mfma_f32_16x16x16_bf16 v[60:63], v[174:175], v[50:51], v[60:63]
    v_add_f32 v29, v29, v34
    v_mfma_f32_16x16x16_bf16 v[56:59], v[176:177], v[52:53], v[56:59]
    v_mfma_f32_16x16x16_bf16 v[60:63], v[178:179], v[52:53], v[60:63]
    v_mfma_f32_16x16x16_bf16 v[56:59], v[180:181], v[54:55], v[56:59]
    v_mfma_f32_16x16x16_bf16 v[60:63], v[182:183], v[54:55], v[60:63]
    s_waitcnt vmcnt(4)
    buffer_load_dwordx4 v[152:155], v0, s[8:11], s80 offen offset:0 nt
    v_fma_f32 v40, v16, s77, -v30
    v_fma_f32 v41, v17, s77, -v30
    v_fma_f32 v42, v18, s77, -v30
    v_fma_f32 v43, v19, s77, -v30
    v_exp_f32 v40, v40
    v_exp_f32 v41, v41
    v_exp_f32 v42, v42
    v_exp_f32 v43, v43
    s_waitcnt vmcnt(4)
    buffer_load_dwordx4 v[156:159], v0, s[8:11], s80 offen offset:1024 nt
    v_cvt_pk_bf16_f32 v44, v40, v40
    v_cvt_pk_bf16_f32 v45, v41, v41
    v_cvt_pk_bf16_f32 v46, v42, v42
    v_cvt_pk_bf16_f32 v47, v43, v43
    v_and_b32 v48, v44, v31
    v_and_b32 v49, v44, v32
    v_and_b32 v50, v45, v31
    v_and_b32 v51, v45, v32
    v_and_b32 v52, v46, v31
    v_and_b32 v53, v46, v32
    v_and_b32 v54, v47, v31
    v_and_b32 v55, v47, v32
    v_add_f32 v33, v40, v41
    v_add_f32 v34, v42, v43
    s_waitcnt vmcnt(4)
    buffer_load_dwordx4 v[160:163], v0, s[8:11], s80 offen offset:2048 nt
    v_mfma_f32_16x16x16_bf16 v[56:59], v[184:185], v[48:49], v[56:59]
    v_mfma_f32_16x16x16_bf16 v[60:63], v[186:187], v[48:49], v[60:63]
    v_add_f32 v29, v29, v33
    v_mfma_f32_16x16x16_bf16 v[56:59], v[188:189], v[50:51], v[56:59]
    v_mfma_f32_16x16x16_bf16 v[60:63], v[190:191], v[50:51], v[60:63]
    v_add_f32 v29, v29, v34
    v_mfma_f32_16x16x16_bf16 v[56:59], v[192:193], v[52:53], v[56:59]
    v_mfma_f32_16x16x16_bf16 v[60:63], v[194:195], v[52:53], v[60:63]
    v_mfma_f32_16x16x16_bf16 v[56:59], v[196:197], v[54:55], v[56:59]
    v_mfma_f32_16x16x16_bf16 v[60:63], v[198:199], v[54:55], v[60:63]
    s_waitcnt vmcnt(4)
    v_mov_b32 v65, 1
    s_mov_b64 exec, 1
    ds_add_rtn_u32 v65, v64, v65
    s_mov_b64 exec, -1
    buffer_load_dwordx4 v[164:167], v0, s[8:11], s80 offen offset:3072 nt
    s_add_u32 s78, s78, 1
    s_waitcnt lgkmcnt(0)
    v_readfirstlane_b32 s82, v65
L_vina4:
    s_sub_u32 s86, s24, 72
    s_lshl_b32 s87, s86, 9
    v_add_u32 v70, s87, v71
    s_lshr_b32 s86, s86, 6
    s_cmp_lg_u32 s86, s56
    s_cbranch_scc1 Lsw_29
Lswr_30:
    ds_read_b128 v[12:15], v70 offset:0
    ds_read_b128 v[16:19], v70 offset:256
    s_cmp_ge_u32 s82, 144
    s_cbranch_scc1 L_fdrain4
    s_sub_u32 s88, s82, s59
    s_sub_u32 s86, s88, s66
    s_cselect_b32 s87, 0, 8
    s_sub_u32 s87, s88, s87
    s_cmp_lt_u32 s86, 8
    s_cselect_b32 s86, s86, s87
    s_cselect_b32 s87, s65, s64
    s_cselect_b32 s88, 64, 0
    s_cselect_b64 s[8:9], s[14:15], s[12:13]
    s_add_u32 s88, s88, s59
    s_add_u32 s23, s88, s86
    s_lshr_b32 s88, s86, 2
    s_lshl_b32 s88, s88, 15
    s_and_b32 s86, s86, 3
    s_lshl_b32 s86, s86, 12
    s_add_u32 s87, s87, s88
    s_add_u32 s81, s87, s86
    s_add_u32 s80, s81, 16384
L_vgoa4:
    s_waitcnt vmcnt(5)
    buffer_load_dwordx4 v[168:171], v0, s[8:11], s81 offen offset:0 nt
    s_waitcnt lgkmcnt(0)
Lnrb_32:
    v_max3_f32 v33, v12, v13, v14
    v_cmp_eq_u32 vcc, 0x7fc0dead, v15
    v_max3_f32 v33, v33, v15, v16
    s_cbranch_vccnz Lnr_31
    v_cmp_eq_u32 vcc, 0x7fc0dead, v19
    v_max3_f32 v33, v33, v17, v18
    s_cbranch_vccnz Lnr_31
    v_max_f32 v33, v33, v19
    v_cmp_gt_f32 vcc, v33, v28
    s_cbranch_vccnz Lrs_33
Lrsb_34:
    v_fma_f32 v40, v12, s77, -v30
    v_fma_f32 v41, v13, s77, -v30
    v_fma_f32 v42, v14, s77, -v30
    v_fma_f32 v43, v15, s77, -v30
    s_waitcnt vmcnt(4)
    buffer_load_dwordx4 v[172:175], v0, s[8:11], s81 offen offset:1024 nt
    v_exp_f32 v40, v40
    v_exp_f32 v41, v41
    v_exp_f32 v42, v42
    v_exp_f32 v43, v43
    v_cvt_pk_bf16_f32 v44, v40, v40
    v_cvt_pk_bf16_f32 v45, v41, v41
    v_cvt_pk_bf16_f32 v46, v42, v42
    v_cvt_pk_bf16_f32 v47, v43, v43
    s_waitcnt vmcnt(4)
    buffer_load_dwordx4 v[176:179], v0, s[8:11], s81 offen offset:2048 nt
    v_and_b32 v48, v44, v31
    v_and_b32 v49, v44, v32
    v_and_b32 v50, v45, v31
    v_and_b32 v51, v45, v32
    v_and_b32 v52, v46, v31
    v_and_b32 v53, v46, v32
    v_and_b32 v54, v47, v31
    v_and_b32 v55, v47, v32
    v_add_f32 v33, v40, v41
    v_add_f32 v34, v42, v43
    s_waitcnt vmcnt(4)
    buffer_load_dwordx4 v[180:183], v0, s[8:11], s81 offen offset:3072 nt
    v_mfma_f32_16x16x16_bf16 v[56:59], v[200:201], v[48:49], v[56:59]
    v_mfma_f32_16x16x16_bf16 v[60:63], v[202:203], v[48:49], v[60:63]
    v_add_f32 v29, v29, v33
    v_mfma_f32_16x16x16_bf16 v[56:59], v[204:205], v[50:51], v[56:59]
    v_mfma_f32_16x16x16_bf16 v[60:63], v[206:207], v[50:51], v[60:63]
    v_add_f32 v29, v29, v34
    v_mfma_f32_16x16x16_bf16 v[56:59], v[208:209], v[52:53], v[56:59]
    v_mfma_f32_16x16x16_bf16 v[60:63], v[210:211], v[52:53], v[60:63]
    v_mfma_f32_16x16x16_bf16 v[56:59], v[212:213], v[54:55], v[56:59]
    v_mfma_f32_16x16x16_bf16 v[60:63], v[214:215], v[54:55], v[60:63]
    s_waitcnt vmcnt(4)
    buffer_load_dwordx4 v[184:187], v0, s[8:11], s80 offen offset:0 nt
    v_fma_f32 v40, v16, s77, -v30
    v_fma_f32 v41, v17, s77, -v30
    v_fma_f32 v42, v18, s77, -v30
    v_fma_f32 v43, v19, s77, -v30
    v_exp_f32 v40, v40
    v_exp_f32 v41, v41
    v_exp_f32 v42, v42
    v_exp_f32 v43, v43
    s_waitcnt vmcnt(4)
    buffer_load_dwordx4 v[188:191], v0, s[8:11], s80 offen offset:1024 nt
    v_cvt_pk_bf16_f32 v44, v40, v40
    v_cvt_pk_bf16_f32 v45, v41, v41
    v_cvt_pk_bf16_f32 v46, v42, v42
    v_cvt_pk_bf16_f32 v47, v43, v43
    v_and_b32 v48, v44, v31
    v_and_b32 v49, v44, v32
    v_and_b32 v50, v45, v31
    v_and_b32 v51, v45, v32
    v_and_b32 v52, v46, v31
    v_and_b32 v53, v46, v32
    v_and_b32 v54, v47, v31
    v_and_b32 v55, v47, v32
    v_add_f32 v33, v40, v41
    v_add_f32 v34, v42, v43
    s_waitcnt vmcnt(4)
    buffer_load_dwordx4 v[192:195], v0, s[8:11], s80 offen offset:2048 nt
    v_mfma_f32_16x16x16_bf16 v[56:59], v[216:217], v[48:49], v[56:59]
    v_mfma_f32_16x16x16_bf16 v[60:63], v[218:219], v[48:49], v[60:63]
    v_add_f32 v29, v29, v33
    v_mfma_f32_16x16x16_bf16 v[56:59], v[220:221], v[50:51], v[56:59]
    v_mfma_f32_16x16x16_bf16 v[60:63], v[222:223], v[50:51], v[60:63]
    v_add_f32 v29, v29, v34
    v_mfma_f32_16x16x16_bf16 v[56:59], v[224:225], v[52:53], v[56:59]
    v_mfma_f32_16x16x16_bf16 v[60:63], v[226:227], v[52:53], v[60:63]
    v_mfma_f32_16x16x16_bf16 v[56:59], v[228:229], v[54:55], v[56:59]
    v_mfma_f32_16x16x16_bf16 v[60:63], v[230:231], v[54:55], v[60:63]
    s_waitcnt vmcnt(4)
    v_mov_b32 v65, 1
    s_mov_b64 exec, 1
    ds_add_rtn_u32 v65, v64, v65
    s_mov_b64 exec, -1
    buffer_load_dwordx4 v[196:199], v0, s[8:11], s80 offen offset:3072 nt
    s_add_u32 s78, s78, 1
    s_waitcnt lgkmcnt(0)
    v_readfirstlane_b32 s82, v65
L_vina2:
    s_sub_u32 s86, s22, 72
    s_lshl_b32 s87, s86, 9
    v_add_u32 v70, s87, v71
    s_lshr_b32 s86, s86, 6
    s_cmp_lg_u32 s86, s56
    s_cbranch_scc1 Lsw_35
Lswr_36:
    ds_read_b128 v[12:15], v70 offset:0
    ds_read_b128 v[16:19], v70 offset:256
    s_cmp_ge_u32 s82, 144
    s_cbranch_scc1 L_fdrain2
    s_sub_u32 s88, s82, s59
    s_sub_u32 s86, s88, s66
    s_cselect_b32 s87, 0, 8
    s_sub_u32 s87, s88, s87
    s_cmp_lt_u32 s86, 8
    s_cselect_b32 s86, s86, s87
    s_cselect_b32 s87, s65, s64
    s_cselect_b32 s88, 64, 0
    s_cselect_b64 s[8:9], s[14:15], s[12:13]
    s_add_u32 s88, s88, s59
    s_add_u32 s24, s88, s86
    s_lshr_b32 s88, s86, 2
    s_lshl_b32 s88, s88, 15
    s_and_b32 s86, s86, 3
    s_lshl_b32 s86, s86, 12
    s_add_u32 s87, s87, s88
    s_add_u32 s81, s87, s86
    s_add_u32 s80, s81, 16384
L_vgoa2:
    s_waitcnt vmcnt(5)
    buffer_load_dwordx4 v[200:203], v0, s[8:11], s81 offen offset:0 nt
    s_waitcnt lgkmcnt(0)
Lnrb_38:
    v_max3_f32 v33, v12, v13, v14
    v_cmp_eq_u32 vcc, 0x7fc0dead, v15
    v_max3_f32 v33, v33, v15, v16
    s_cbranch_vccnz Lnr_37
    v_cmp_eq_u32 vcc, 0x7fc0dead, v19
    v_max3_f32 v33, v33, v17, v18
    s_cbranch_vccnz Lnr_37
    v_max_f32 v33, v33, v19
    v_cmp_gt_f32 vcc, v33, v28
    s_cbranch_vccnz Lrs_39
Lrsb_40:
    v_fma_f32 v40, v12, s77, -v30
    v_fma_f32 v41, v13, s77, -v30
    v_fma_f32 v42, v14, s77, -v30
    v_fma_f32 v43, v15, s77, -v30
    s_waitcnt vmcnt(4)
    buffer_load_dwordx4 v[204:207], v0, s[8:11], s81 offen offset:1024 nt
    v_exp_f32 v40, v40
    v_exp_f32 v41, v41
    v_exp_f32 v42, v42
    v_exp_f32 v43, v43
    v_cvt_pk_bf16_f32 v44, v40, v40
    v_cvt_pk_bf16_f32 v45, v41, v41
    v_cvt_pk_bf16_f32 v46, v42, v42
    v_cvt_pk_bf16_f32 v47, v43, v43
    s_waitcnt vmcnt(4)
    buffer_load_dwordx4 v[208:211], v0, s[8:11], s81 offen offset:2048 nt
    v_and_b32 v48, v44, v31
    v_and_b32 v49, v44, v32
    v_and_b32 v50, v45, v31
    v_and_b32 v51, v45, v32
    v_and_b32 v52, v46, v31
    v_and_b32 v53, v46, v32
    v_and_b32 v54, v47, v31
    v_and_b32 v55, v47, v32
    v_add_f32 v33, v40, v41
    v_add_f32 v34, v42, v43
    s_waitcnt vmcnt(4)
    buffer_load_dwordx4 v[212:215], v0, s[8:11], s81 offen offset:3072 nt
    v_mfma_f32_16x16x16_bf16 v[56:59], v[136:137], v[48:49], v[56:59]
    v_mfma_f32_16x16x16_bf16 v[60:63], v[138:139], v[48:49], v[60:63]
    v_add_f32 v29, v29, v33
    v_mfma_f32_16x16x16_bf16 v[56:59], v[140:141], v[50:51], v[56:59]
    v_mfma_f32_16x16x16_bf16 v[60:63], v[142:143], v[50:51], v[60:63]
    v_add_f32 v29, v29, v34
    v_mfma_f32_16x16x16_bf16 v[56:59], v[144:145], v[52:53], v[56:59]
    v_mfma_f32_16x16x16_bf16 v[60:63], v[146:147], v[52:53], v[60:63]
    v_mfma_f32_16x16x16_bf16 v[56:59], v[148:149], v[54:55], v[56:59]
    v_mfma_f32_16x16x16_bf16 v[60:63], v[150:151], v[54:55], v[60:63]
    s_waitcnt vmcnt(4)
    buffer_load_dwordx4 v[216:219], v0, s[8:11], s80 offen offset:0 nt
    v_fma_f32 v40, v16, s77, -v30
    v_fma_f32 v41, v17, s77, -v30
    v_fma_f32 v42, v18, s77, -v30
    v_fma_f32 v43, v19, s77, -v30
    v_exp_f32 v40, v40
    v_exp_f32 v41, v41
    v_exp_f32 v42, v42
    v_exp_f32 v43, v43
    s_waitcnt vmcnt(4)
    buffer_load_dwordx4 v[220:223], v0, s[8:11], s80 offen offset:1024 nt
    v_cvt_pk_bf16_f32 v44, v40, v40
    v_cvt_pk_bf16_f32 v45, v41, v41
    v_cvt_pk_bf16_f32 v46, v42, v42
    v_cvt_pk_bf16_f32 v47, v43, v43
    v_and_b32 v48, v44, v31
    v_and_b32 v49, v44, v32
    v_and_b32 v50, v45, v31
    v_and_b32 v51, v45, v32
    v_and_b32 v52, v46, v31
    v_and_b32 v53, v46, v32
    v_and_b32 v54, v47, v31
    v_and_b32 v55, v47, v32
    v_add_f32 v33, v40, v41
    v_add_f32 v34, v42, v43
    s_waitcnt vmcnt(4)
    buffer_load_dwordx4 v[224:227], v0, s[8:11], s80 offen offset:2048 nt
    v_mfma_f32_16x16x16_bf16 v[56:59], v[152:153], v[48:49], v[56:59]
    v_mfma_f32_16x16x16_bf16 v[60:63], v[154:155], v[48:49], v[60:63]
    v_add_f32 v29, v29, v33
    v_mfma_f32_16x16x16_bf16 v[56:59], v[156:157], v[50:51], v[56:59]
    v_mfma_f32_16x16x16_bf16 v[60:63], v[158:159], v[50:51], v[60:63]
    v_add_f32 v29, v29, v34
    v_mfma_f32_16x16x16_bf16 v[56:59], v[160:161], v[52:53], v[56:59]
    v_mfma_f32_16x16x16_bf16 v[60:63], v[162:163], v[52:53], v[60:63]
    v_mfma_f32_16x16x16_bf16 v[56:59], v[164:165], v[54:55], v[56:59]
    v_mfma_f32_16x16x16_bf16 v[60:63], v[166:167], v[54:55], v[60:63]
    s_waitcnt vmcnt(4)
    v_mov_b32 v65, 1
    s_mov_b64 exec, 1
    ds_add_rtn_u32 v65, v64, v65
    s_mov_b64 exec, -1
    buffer_load_dwordx4 v[228:231], v0, s[8:11], s80 offen offset:3072 nt
    s_add_u32 s78, s78, 1
    s_branch L_vloopa
L_fdrain3:
    s_mov_b32 s6, 1
    s_branch L_dgo3
L_fdrain4:
    s_mov_b32 s6, 1
    s_branch L_dgo4
L_fdrain2:
    s_mov_b32 s6, 1
    s_branch L_dgo2
L_dloop:
    s_sub_u32 s6, s6, 1
    s_cbranch_scc1 L_exit
    s_sub_u32 s86, s23, 72
    s_lshl_b32 s87, s86, 9
    v_add_u32 v70, s87, v71
    s_lshr_b32 s86, s86, 6
    s_cmp_lg_u32 s86, s56
    s_cbranch_scc1 Lsw_41
Lswr_42:
    ds_read_b128 v[12:15], v70 offset:0
    ds_read_b128 v[16:19], v70 offset:256
    s_waitcnt vmcnt(0)
L_dgo3:
    s_waitcnt lgkmcnt(0)
Lnrb_44:
    v_max3_f32 v33, v12, v13, v14
    v_cmp_eq_u32 vcc, 0x7fc0dead, v15
    v_max3_f32 v33, v33, v15, v16
    s_cbranch_vccnz Lnr_43
    v_cmp_eq_u32 vcc, 0x7fc0dead, v19
    v_max3_f32 v33, v33, v17, v18
    s_cbranch_vccnz Lnr_43
    v_max_f32 v33, v33, v19
    v_cmp_gt_f32 vcc, v33, v28
    s_cbranch_vccnz Lrs_45
Lrsb_46:
    v_fma_f32 v40, v12, s77, -v30
    v_fma_f32 v41, v13, s77, -v30
    v_fma_f32 v42, v14, s77, -v30
    v_fma_f32 v43, v15, s77, -v30
    v_exp_f32 v40, v40
    v_exp_f32 v41, v41
    v_exp_f32 v42, v42
    v_exp_f32 v43, v43
    v_cvt_pk_bf16_f32 v44, v40, v40
    v_cvt_pk_bf16_f32 v45, v41, v41
    v_cvt_pk_bf16_f32 v46, v42, v42
    v_cvt_pk_bf16_f32 v47, v43, v43
    v_and_b32 v48, v44, v31
    v_and_b32 v49, v44, v32
    v_and_b32 v50, v45, v31
    v_and_b32 v51, v45, v32
    v_and_b32 v52, v46, v31
    v_and_b32 v53, v46, v32
    v_and_b32 v54, v47, v31
    v_and_b32 v55, v47, v32
    v_add_f32 v33, v40, v41
    v_add_f32 v34, v42, v43
    v_mfma_f32_16x16x16_bf16 v[56:59], v[168:169], v[48:49], v[56:59]
    v_mfma_f32_16x16x16_bf16 v[60:63], v[170:171], v[48:49], v[60:63]
    v_add_f32 v29, v29, v33
    v_mfma_f32_16x16x16_bf16 v[56:59], v[172:173], v[50:51], v[56:59]
    v_mfma_f32_16x16x16_bf16 v[60:63], v[174:175], v[50:51], v[60:63]
    v_add_f32 v29, v29, v34
    v_mfma_f32_16x16x16_bf16 v[56:59], v[176:177], v[52:53], v[56:59]
    v_mfma_f32_16x16x16_bf16 v[60:63], v[178:179], v[52:53], v[60:63]
    v_mfma_f32_16x16x16_bf16 v[56:59], v[180:181], v[54:55], v[56:59]
    v_mfma_f32_16x16x16_bf16 v[60:63], v[182:183], v[54:55], v[60:63]
    v_fma_f32 v40, v16, s77, -v30
    v_fma_f32 v41, v17, s77, -v30
    v_fma_f32 v42, v18, s77, -v30
    v_fma_f32 v43, v19, s77, -v30
    v_exp_f32 v40, v40
    v_exp_f32 v41, v41
    v_exp_f32 v42, v42
    v_exp_f32 v43, v43
    v_cvt_pk_bf16_f32 v44, v40, v40
    v_cvt_pk_bf16_f32 v45, v41, v41
    v_cvt_pk_bf16_f32 v46, v42, v42
    v_cvt_pk_bf16_f32 v47, v43, v43
    v_and_b32 v48, v44, v31
    v_and_b32 v49, v44, v32
    v_and_b32 v50, v45, v31
    v_and_b32 v51, v45, v32
    v_and_b32 v52, v46, v31
    v_and_b32 v53, v46, v32
    v_and_b32 v54, v47, v31
    v_and_b32 v55, v47, v32
    v_add_f32 v33, v40, v41
    v_add_f32 v34, v42, v43
    v_mfma_f32_16x16x16_bf16 v[56:59], v[184:185], v[48:49], v[56:59]
    v_mfma_f32_16x16x16_bf16 v[60:63], v[186:187], v[48:49], v[60:63]
    v_add_f32 v29, v29, v33
    v_mfma_f32_16x16x16_bf16 v[56:59], v[188:189], v[50:51], v[56:59]
    v_mfma_f32_16x16x16_bf16 v[60:63], v[190:191], v[50:51], v[60:63]
    v_add_f32 v29, v29, v34
    v_mfma_f32_16x16x16_bf16 v[56:59], v[192:193], v[52:53], v[56:59]
    v_mfma_f32_16x16x16_bf16 v[60:63], v[194:195], v[52:53], v[60:63]
    v_mfma_f32_16x16x16_bf16 v[56:59], v[196:197], v[54:55], v[56:59]
    v_mfma_f32_16x16x16_bf16 v[60:63], v[198:199], v[54:55], v[60:63]
    s_add_u32 s78, s78, 1
    s_sub_u32 s6, s6, 1
    s_cbranch_scc1 L_exit
    s_sub_u32 s86, s24, 72
    s_lshl_b32 s87, s86, 9
    v_add_u32 v70, s87, v71
    s_lshr_b32 s86, s86, 6
    s_cmp_lg_u32 s86, s56
    s_cbranch_scc1 Lsw_47
Lswr_48:
    ds_read_b128 v[12:15], v70 offset:0
    ds_read_b128 v[16:19], v70 offset:256
    s_waitcnt vmcnt(0)
L_dgo4:
    s_waitcnt lgkmcnt(0)
Lnrb_50:
    v_max3_f32 v33, v12, v13, v14
    v_cmp_eq_u32 vcc, 0x7fc0dead, v15
    v_max3_f32 v33, v33, v15, v16
    s_cbranch_vccnz Lnr_49
    v_cmp_eq_u32 vcc, 0x7fc0dead, v19
    v_max3_f32 v33, v33, v17, v18
    s_cbranch_vccnz Lnr_49
    v_max_f32 v33, v33, v19
    v_cmp_gt_f32 vcc, v33, v28
    s_cbranch_vccnz Lrs_51
Lrsb_52:
    v_fma_f32 v40, v12, s77, -v30
    v_fma_f32 v41, v13, s77, -v30
    v_fma_f32 v42, v14, s77, -v30
    v_fma_f32 v43, v15, s77, -v30
    v_exp_f32 v40, v40
    v_exp_f32 v41, v41
    v_exp_f32 v42, v42
    v_exp_f32 v43, v43
    v_cvt_pk_bf16_f32 v44, v40, v40
    v_cvt_pk_bf16_f32 v45, v41, v41
    v_cvt_pk_bf16_f32 v46, v42, v42
    v_cvt_pk_bf16_f32 v47, v43, v43
    v_and_b32 v48, v44, v31
    v_and_b32 v49, v44, v32
    v_and_b32 v50, v45, v31
    v_and_b32 v51, v45, v32
    v_and_b32 v52, v46, v31
    v_and_b32 v53, v46, v32
    v_and_b32 v54, v47, v31
    v_and_b32 v55, v47, v32
    v_add_f32 v33, v40, v41
    v_add_f32 v34, v42, v43
    v_mfma_f32_16x16x16_bf16 v[56:59], v[200:201], v[48:49], v[56:59]
    v_mfma_f32_16x16x16_bf16 v[60:63], v[202:203], v[48:49], v[60:63]
    v_add_f32 v29, v29, v33
    v_mfma_f32_16x16x16_bf16 v[56:59], v[204:205], v[50:51], v[56:59]
    v_mfma_f32_16x16x16_bf16 v[60:63], v[206:207], v[50:51], v[60:63]
    v_add_f32 v29, v29, v34
    v_mfma_f32_16x16x16_bf16 v[56:59], v[208:209], v[52:53], v[56:59]
    v_mfma_f32_16x16x16_bf16 v[60:63], v[210:211], v[52:53], v[60:63]
    v_mfma_f32_16x16x16_bf16 v[56:59], v[212:213], v[54:55], v[56:59]
    v_mfma_f32_16x16x16_bf16 v[60:63], v[214:215], v[54:55], v[60:63]
    v_fma_f32 v40, v16, s77, -v30
    v_fma_f32 v41, v17, s77, -v30
    v_fma_f32 v42, v18, s77, -v30
    v_fma_f32 v43, v19, s77, -v30
    v_exp_f32 v40, v40
    v_exp_f32 v41, v41
    v_exp_f32 v42, v42
    v_exp_f32 v43, v43
    v_cvt_pk_bf16_f32 v44, v40, v40
    v_cvt_pk_bf16_f32 v45, v41, v41
    v_cvt_pk_bf16_f32 v46, v42, v42
    v_cvt_pk_bf16_f32 v47, v43, v43
    v_and_b32 v48, v44, v31
    v_and_b32 v49, v44, v32
    v_and_b32 v50, v45, v31
    v_and_b32 v51, v45, v32
    v_and_b32 v52, v46, v31
    v_and_b32 v53, v46, v32
    v_and_b32 v54, v47, v31
    v_and_b32 v55, v47, v32
    v_add_f32 v33, v40, v41
    v_add_f32 v34, v42, v43
    v_mfma_f32_16x16x16_bf16 v[56:59], v[216:217], v[48:49], v[56:59]
    v_mfma_f32_16x16x16_bf16 v[60:63], v[218:219], v[48:49], v[60:63]
    v_add_f32 v29, v29, v33
    v_mfma_f32_16x16x16_bf16 v[56:59], v[220:221], v[50:51], v[56:59]
    v_mfma_f32_16x16x16_bf16 v[60:63], v[222:223], v[50:51], v[60:63]
    v_add_f32 v29, v29, v34
    v_mfma_f32_16x16x16_bf16 v[56:59], v[224:225], v[52:53], v[56:59]
    v_mfma_f32_16x16x16_bf16 v[60:63], v[226:227], v[52:53], v[60:63]
    v_mfma_f32_16x16x16_bf16 v[56:59], v[228:229], v[54:55], v[56:59]
    v_mfma_f32_16x16x16_bf16 v[60:63], v[230:231], v[54:55], v[60:63]
    s_add_u32 s78, s78, 1
    s_sub_u32 s6, s6, 1
    s_cbranch_scc1 L_exit
    s_sub_u32 s86, s22, 72
    s_lshl_b32 s87, s86, 9
    v_add_u32 v70, s87, v71
    s_lshr_b32 s86, s86, 6
    s_cmp_lg_u32 s86, s56
    s_cbranch_scc1 Lsw_53
Lswr_54:
    ds_read_b128 v[12:15], v70 offset:0
    ds_read_b128 v[16:19], v70 offset:256
    s_waitcnt vmcnt(0)
L_dgo2:
    s_waitcnt lgkmcnt(0)
Lnrb_56:
    v_max3_f32 v33, v12, v13, v14
    v_cmp_eq_u32 vcc, 0x7fc0dead, v15
    v_max3_f32 v33, v33, v15, v16
    s_cbranch_vccnz Lnr_55
    v_cmp_eq_u32 vcc, 0x7fc0dead, v19
    v_max3_f32 v33, v33, v17, v18
    s_cbranch_vccnz Lnr_55
    v_max_f32 v33, v33, v19
    v_cmp_gt_f32 vcc, v33, v28
    s_cbranch_vccnz Lrs_57
Lrsb_58:
    v_fma_f32 v40, v12, s77, -v30
    v_fma_f32 v41, v13, s77, -v30
    v_fma_f32 v42, v14, s77, -v30
    v_fma_f32 v43, v15, s77, -v30
    v_exp_f32 v40, v40
    v_exp_f32 v41, v41
    v_exp_f32 v42, v42
    v_exp_f32 v43, v43
    v_cvt_pk_bf16_f32 v44, v40, v40
    v_cvt_pk_bf16_f32 v45, v41, v41
    v_cvt_pk_bf16_f32 v46, v42, v42
    v_cvt_pk_bf16_f32 v47, v43, v43
    v_and_b32 v48, v44, v31
    v_and_b32 v49, v44, v32
    v_and_b32 v50, v45, v31
    v_and_b32 v51, v45, v32
    v_and_b32 v52, v46, v31
    v_and_b32 v53, v46, v32
    v_and_b32 v54, v47, v31
    v_and_b32 v55, v47, v32
    v_add_f32 v33, v40, v41
    v_add_f32 v34, v42, v43
    v_mfma_f32_16x16x16_bf16 v[56:59], v[136:137], v[48:49], v[56:59]
    v_mfma_f32_16x16x16_bf16 v[60:63], v[138:139], v[48:49], v[60:63]
    v_add_f32 v29, v29, v33
    v_mfma_f32_16x16x16_bf16 v[56:59], v[140:141], v[50:51], v[56:59]
    v_mfma_f32_16x16x16_bf16 v[60:63], v[142:143], v[50:51], v[60:63]
    v_add_f32 v29, v29, v34
    v_mfma_f32_16x16x16_bf16 v[56:59], v[144:145], v[52:53], v[56:59]
    v_mfma_f32_16x16x16_bf16 v[60:63], v[146:147], v[52:53], v[60:63]
    v_mfma_f32_16x16x16_bf16 v[56:59], v[148:149], v[54:55], v[56:59]
    v_mfma_f32_16x16x16_bf16 v[60:63], v[150:151], v[54:55], v[60:63]
    v_fma_f32 v40, v16, s77, -v30
    v_fma_f32 v41, v17, s77, -v30
    v_fma_f32 v42, v18, s77, -v30
    v_fma_f32 v43, v19, s77, -v30
    v_exp_f32 v40, v40
    v_exp_f32 v41, v41
    v_exp_f32 v42, v42
    v_exp_f32 v43, v43
    v_cvt_pk_bf16_f32 v44, v40, v40
    v_cvt_pk_bf16_f32 v45, v41, v41
    v_cvt_pk_bf16_f32 v46, v42, v42
    v_cvt_pk_bf16_f32 v47, v43, v43
    v_and_b32 v48, v44, v31
    v_and_b32 v49, v44, v32
    v_and_b32 v50, v45, v31
    v_and_b32 v51, v45, v32
    v_and_b32 v52, v46, v31
    v_and_b32 v53, v46, v32
    v_and_b32 v54, v47, v31
    v_and_b32 v55, v47, v32
    v_add_f32 v33, v40, v41
    v_add_f32 v34, v42, v43
    v_mfma_f32_16x16x16_bf16 v[56:59], v[152:153], v[48:49], v[56:59]
    v_mfma_f32_16x16x16_bf16 v[60:63], v[154:155], v[48:49], v[60:63]
    v_add_f32 v29, v29, v33
    v_mfma_f32_16x16x16_bf16 v[56:59], v[156:157], v[50:51], v[56:59]
    v_mfma_f32_16x16x16_bf16 v[60:63], v[158:159], v[50:51], v[60:63]
    v_add_f32 v29, v29, v34
    v_mfma_f32_16x16x16_bf16 v[56:59], v[160:161], v[52:53], v[56:59]
    v_mfma_f32_16x16x16_bf16 v[60:63], v[162:163], v[52:53], v[60:63]
    v_mfma_f32_16x16x16_bf16 v[56:59], v[164:165], v[54:55], v[56:59]
    v_mfma_f32_16x16x16_bf16 v[60:63], v[166:167], v[54:55], v[60:63]
    s_add_u32 s78, s78, 1
    s_branch L_dloop
Lsw_5:
    s_call_b64 s[4:5], L_swapq
    s_branch Lswr_6
Lsw_7:
    s_call_b64 s[4:5], L_swapq
    s_branch Lswr_8
Lsw_9:
    s_call_b64 s[4:5], L_swapq
    s_branch Lswr_10
Lsw_13:
    s_call_b64 s[4:5], L_swapq
    s_branch Lswr_14
Ltov_11:
    s_call_b64 s[4:5], L_tov
    s_branch Ltovr_12
Lsw_17:
    s_call_b64 s[4:5], L_swapq
    s_branch Lswr_18
Ltov_15:
    s_call_b64 s[4:5], L_tov
    s_branch Ltovr_16
Lsw_21:
    s_call_b64 s[4:5], L_swapq
    s_branch Lswr_22
Ltov_19:
    s_call_b64 s[4:5], L_tov
    s_branch Ltovr_20
Lsw_23:
    s_call_b64 s[4:5], L_swap
    s_branch Lswr_24
Lnr_25:
    s_call_b64 s[4:5], L_reread
    s_branch Lnrb_26
Lrs_27:
    s_call_b64 s[4:5], L_resc
    s_branch Lrsb_28
Lsw_29:
    s_call_b64 s[4:5], L_swap
    s_branch Lswr_30
Lnr_31:
    s_call_b64 s[4:5], L_reread
    s_branch Lnrb_32
Lrs_33:
    s_call_b64 s[4:5], L_resc
    s_branch Lrsb_34
Lsw_35:
    s_call_b64 s[4:5], L_swap
    s_branch Lswr_36
Lnr_37:
    s_call_b64 s[4:5], L_reread
    s_branch Lnrb_38
Lrs_39:
    s_call_b64 s[4:5], L_resc
    s_branch Lrsb_40
Lsw_41:
    s_call_b64 s[4:5], L_swap
    s_branch Lswr_42
Lnr_43:
    s_call_b64 s[4:5], L_reread
    s_branch Lnrb_44
Lrs_45:
    s_call_b64 s[4:5], L_resc
    s_branch Lrsb_46
Lsw_47:
    s_call_b64 s[4:5], L_swap
    s_branch Lswr_48
Lnr_49:
    s_call_b64 s[4:5], L_reread
    s_branch Lnrb_50
Lrs_51:
    s_call_b64 s[4:5], L_resc
    s_branch Lrsb_52
Lsw_53:
    s_call_b64 s[4:5], L_swap
    s_branch Lswr_54
Lnr_55:
    s_call_b64 s[4:5], L_reread
    s_branch Lnrb_56
Lrs_57:
    s_call_b64 s[4:5], L_resc
    s_branch Lrsb_58
L_tov:
    s_mov_b64 s[12:13], s[16:17]
    s_mov_b64 s[14:15], s[18:19]
    s_mov_b32 s59, 72
    s_mov_b32 s66, 64
    s_mov_b32 s58, 0x7fffffff
    v_mov_b32 v0, v2
    s_setpc_b64 s[4:5]
L_swapq:
    s_xor_b32 s56, s56, 1
    v_swap_b32 v4, v8
    v_swap_b32 v5, v9
    v_swap_b32 v6, v10
    v_swap_b32 v7, v11
    s_setpc_b64 s[4:5]
L_swap:
    s_nop 3
    s_xor_b32 s56, s56, 1
    v_swap_b32 v28, v240
    v_swap_b32 v29, v241
    v_swap_b32 v30, v242
    v_swap_b32 v56, v232
    v_swap_b32 v57, v233
    v_swap_b32 v58, v234
    v_swap_b32 v59, v235
    v_swap_b32 v60, v236
    v_swap_b32 v61, v237
    v_swap_b32 v62, v238
    v_swap_b32 v63, v239
    s_setpc_b64 s[4:5]
L_reread:
    s_sub_u32 s84, s84, 1
    s_cbranch_scc1 L_end
    ds_read_b128 v[12:15], v70 offset:0
    ds_read_b128 v[16:19], v70 offset:256
    s_waitcnt lgkmcnt(0)
    s_setpc_b64 s[4:5]
L_resc:
    v_max_f32 v33, v33, v28
    v_mov_b32 v34, v33
    s_nop 1
    v_permlane16_swap_b32 v33, v34
    v_max_f32 v33, v33, v34
    v_mov_b32 v34, v33
    s_nop 1
    v_permlane32_swap_b32 v33, v34
    v_max_f32 v28, v33, v34
    v_mul_f32 v33, s77, v28
    v_sub_f32 v35, v30, v33
    v_exp_f32 v35, v35
    v_mov_b32 v30, v33
    v_mul_f32 v56, v56, v35
    v_mul_f32 v57, v57, v35
    v_mul_f32 v58, v58, v35
    v_mul_f32 v59, v59, v35
    v_mul_f32 v60, v60, v35
    v_mul_f32 v61, v61, v35
    v_mul_f32 v62, v62, v35
    v_mul_f32 v63, v63, v35
    v_mul_f32 v29, v29, v35
    s_setpc_b64 s[4:5]
L_exit:
    v_mov_b32 v34, v29
    v_mov_b32 v35, v241
    s_mul_i32 s86, s44, 2176
    s_mul_i32 s87, s56, 8704
    v_permlane16_swap_b32 v29, v34
    v_permlane16_swap_b32 v241, v35
    s_add_u32 s88, s86, s87
    v_add_f32 v29, v29, v34
    v_add_f32 v241, v241, v35
    s_sub_u32 s86, s86, s87
    v_mov_b32 v34, v29
    v_mov_b32 v35, v241
    s_add_u32 s86, s86, 8704
    v_add_u32 v33, s86, v2
    v_permlane32_swap_b32 v29, v34
    v_permlane32_swap_b32 v241, v35
    v_add_u32 v70, s88, v2
    ds_write_b128 v33, v[56:59] offset:36864
    ds_write_b128 v33, v[60:63] offset:37952
    v_add_f32 v29, v29, v34
    v_add_f32 v241, v241, v35
    s_lshl_b32 s87, s56, 7
    ds_write_b128 v70, v[232:235] offset:36864
    ds_write_b128 v70, v[236:239] offset:37952
    v_add_u32 v35, s87, v249
    v_subrev_u32 v33, s87, v249
    v_add_u32 v33, 128, v33
    s_mov_b64 exec, 0x1111
    ds_write_b64 v33, v[28:29] offset:54272
    ds_write_b64 v35, v[240:241] offset:54272
    s_mov_b64 exec, -1
    buffer_load_dwordx4 v[104:107], v248, s[28:31], s48 offen offset:0 nt
    buffer_load_dwordx4 v[108:111], v248, s[28:31], s48 offen offset:1024 nt
    buffer_load_dwordx4 v[112:115], v248, s[28:31], s48 offen offset:2048 nt
    buffer_load_dwordx4 v[116:119], v248, s[28:31], s48 offen offset:3072 nt
    buffer_load_dwordx4 v[120:123], v248, s[28:31], s49 offen offset:0 nt
    buffer_load_dwordx4 v[124:127], v248, s[28:31], s49 offen offset:1024 nt
    buffer_load_dwordx4 v[128:131], v248, s[28:31], s49 offen offset:2048 nt
    buffer_load_dwordx4 v[132:135], v248, s[28:31], s49 offen offset:3072 nt
    s_lshl_b32 s86, s7, 3
    s_or_b32 s86, s86, s44
    s_cmp_lg_u32 s86, 3
    s_cbranch_scc1 Lnogate_59
    s_lshl_b32 s86, s2, 7
    s_and_b32 s86, s86, 1024
    buffer_load_dwordx4 v[168:171], v2, s[36:39], s86 offen
    global_load_dwordx4 v[172:175], v2, s[68:69]
Lnogate_59:
    s_waitcnt lgkmcnt(0)
    s_barrier
    ds_read_b128 v[72:75], v251 offset:54272
    ds_read_b128 v[76:79], v251 offset:54288
    ds_read_b128 v[80:83], v250 offset:36864
    ds_read_b128 v[84:87], v250 offset:39040
    ds_read_b128 v[88:91], v250 offset:41216
    ds_read_b128 v[92:95], v250 offset:43392
    v_mov_b32 v17, v68
    v_mov_b32 v19, v68
    v_lshlrev_b32 v70, 1, v3
    s_waitcnt lgkmcnt(4)
    v_max3_f32 v16, v72, v74, v76
    v_max_f32 v16, v16, v78
    v_mul_f32 v35, s77, v16
    v_fma_f32 v72, v72, s77, -v35
    v_fma_f32 v74, v74, s77, -v35
    v_fma_f32 v76, v76, s77, -v35
    v_fma_f32 v78, v78, s77, -v35
    v_exp_f32 v72, v72
    v_exp_f32 v74, v74
    v_exp_f32 v76, v76
    v_exp_f32 v78, v78
    s_waitcnt lgkmcnt(0)
    v_mul_f32 v20, v72, v80
    v_mul_f32 v21, v72, v81
    v_mul_f32 v22, v72, v82
    v_mul_f32 v23, v72, v83
    v_fmac_f32 v20, v74, v84
    v_fmac_f32 v21, v74, v85
    v_fmac_f32 v22, v74, v86
    v_fmac_f32 v23, v74, v87
    v_fmac_f32 v20, v76, v88
    v_fmac_f32 v21, v76, v89
    v_fmac_f32 v22, v76, v90
    v_fmac_f32 v23, v76, v91
    v_fmac_f32 v20, v78, v92
    v_fmac_f32 v21, v78, v93
    v_fmac_f32 v22, v78, v94
    v_fmac_f32 v23, v78, v95
    v_and_or_b32 v20, v20, s91, v244
    v_and_or_b32 v21, v21, s91, v245
    v_and_or_b32 v22, v22, s91, v246
    v_and_or_b32 v23, v23, s91, v247
    buffer_store_dwordx4 v[20:23], v2, s[32:35], s50 offen sc1
    s_bitcmp1_b32 s44, 0
    s_cbranch_scc1 L_t2
    v_mul_f32 v18, v72, v73
    v_fmac_f32 v18, v74, v75
    v_fmac_f32 v18, v76, v77
    v_fmac_f32 v18, v78, v79
    s_mov_b32 exec_lo, 0x01010101
    s_mov_b32 exec_hi, 0x01010101
    buffer_store_dwordx4 v[16:19], v70, s[32:35], s51 offen sc1
    s_mov_b64 exec, -1
L_t2:
    v_and_b32 v33, 1, v3
    v_lshlrev_b32 v33, 4, v33
    v_mov_b32 v34, 0xffff
    v_lshlrev_b32 v34, v33, v34
    v_bfe_u32 v33, v3, 1, 2
    v_cmp_eq_u32 vcc, 0, v33
    s_nop 1
    v_cndmask_b32 v4, 0, v34, vcc
    v_cmp_eq_u32 vcc, 1, v33
    s_nop 1
    v_cndmask_b32 v5, 0, v34, vcc
    v_cmp_eq_u32 vcc, 2, v33
    s_nop 1
    v_cndmask_b32 v6, 0, v34, vcc
    v_cmp_eq_u32 vcc, 3, v33
    s_nop 1
    v_cndmask_b32 v7, 0, v34, vcc
    s_bitcmp1_b32 s44, 0
    s_cbranch_scc0 L_t3
    s_lshr_b32 s86, s44, 1
    s_lshl_b32 s86, s86, 7
    v_lshrrev_b32 v33, 4, v3
    v_lshlrev_b32 v33, 5, v33
    v_and_b32 v34, 7, v3
    v_lshl_add_u32 v33, v34, 2, v33
    v_add_u32 v33, s86, v33
    s_sleep 16
Lpoll_60:
    buffer_load_dwordx4 v[80:83], v253, s[32:35], s62 offen sc1
    buffer_load_dwordx4 v[84:87], v253, s[32:35], s62 offen offset:1024 sc1
    buffer_load_dwordx4 v[72:75], v252, s[32:35], s60 offen sc1
    buffer_load_dwordx4 v[76:79], v252, s[32:35], s61 offen sc1
    s_mov_b64 exec, -1
    s_sub_u32 s84, s84, 1
    s_cbranch_scc1 L_end
    s_waitcnt vmcnt(0)
    v_perm_b32 v36, v73, v72, s89
    v_perm_b32 v37, v75, v74, s90
    v_or_b32 v36, v36, v37
    v_xor_b32 v36, v36, v68
    v_perm_b32 v37, v77, v76, s89
    v_perm_b32 v38, v79, v78, s90
    v_or_b32 v37, v37, v38
    v_xor_b32 v37, v37, v68
    v_xor_b32 v38, v81, v68
    v_xor_b32 v39, v83, v68
    v_xor_b32 v40, v85, v68
    v_xor_b32 v41, v87, v68
    v_or_b32 v36, v36, v37
    v_or_b32 v36, v36, v38
    v_or_b32 v36, v36, v39
    v_or_b32 v36, v36, v40
    v_or_b32 v36, v36, v41
    v_cmp_ne_u32 vcc, 0, v36
    s_cbranch_vccz Lpok_61
    s_mov_b64 exec, vcc
    s_branch Lpoll_60
Lpok_61:
    v_max_f32 v36, v80, v84
    s_nop 1
    v_max_f32_dpp v36, v36, v36 row_ror:8 row_mask:0xf bank_mask:0xf
    v_mov_b32 v44, v36
    s_nop 1
    v_permlane16_swap_b32 v36, v44
    v_max_f32 v36, v36, v44
    v_mov_b32 v44, v36
    s_nop 1
    v_permlane32_swap_b32 v36, v44
    v_max_f32 v36, v36, v44
    v_mul_f32 v36, s77, v36
    v_fma_f32 v80, v80, s77, -v36
    v_fma_f32 v84, v84, s77, -v36
    v_exp_f32 v80, v80
    v_exp_f32 v84, v84
    s_nop 0
    v_mul_f32 v37, v80, v82
    v_mul_f32 v38, v80, v72
    v_mul_f32 v39, v80, v73
    v_mul_f32 v40, v80, v74
    v_mul_f32 v41, v80, v75
    v_fmac_f32 v37, v84, v86
    v_fmac_f32 v38, v84, v76
    v_fmac_f32 v39, v84, v77
    v_fmac_f32 v40, v84, v78
    v_fmac_f32 v41, v84, v79
    v_mov_b32 v44, v37
    s_nop 0
    v_permlane32_swap_b32 v38, v40
    v_permlane32_swap_b32 v39, v41
    v_permlane32_swap_b32 v37, v44
    v_add_f32 v38, v38, v40
    v_add_f32 v39, v39, v41
    v_add_f32 v37, v37, v44
    v_mov_b32 v44, v37
    s_nop 1
    v_permlane16_swap_b32 v37, v44
    v_permlane16_swap_b32 v38, v39
    v_add_f32 v37, v37, v44
    v_add_f32 v38, v38, v39
    s_nop 0
    v_add_f32_dpp v37, v37, v37 row_ror:8 row_mask:0xf bank_mask:0xf
    v_add_f32_dpp v38, v38, v38 row_ror:8 row_mask:0xf bank_mask:0xf
    v_rcp_f32 v37, v37
    s_mov_b32 exec_lo, 0x00ff00ff
    s_mov_b32 exec_hi, 0x00ff00ff
    v_mul_f32 v38, v38, v37
    v_cvt_pk_bf16_f32 v38, v38, v38
    ds_write_b32 v33, v38 offset:55552
    s_mov_b64 exec, -1
L_t3:
    s_waitcnt vmcnt(0) lgkmcnt(0)
    s_barrier
    ds_read_b128 v[72:75], v254 offset:55552
    ds_read_b128 v[76:79], v254 offset:55568
    s_waitcnt lgkmcnt(1)
    v_and_b32 v136, v72, v4
    v_and_b32 v137, v72, v5
    v_and_b32 v138, v72, v6
    v_and_b32 v139, v72, v7
    v_and_b32 v140, v73, v4
    v_and_b32 v141, v73, v5
    v_and_b32 v142, v73, v6
    v_and_b32 v143, v73, v7
    v_mfma_f32_16x16x32_bf16 v[20:23], v[104:107], v[136:139], 0
    v_and_b32 v144, v74, v4
    v_and_b32 v145, v74, v5
    v_and_b32 v146, v74, v6
    v_and_b32 v147, v74, v7
    v_mfma_f32_16x16x32_bf16 v[20:23], v[108:111], v[140:143], v[20:23]
    v_and_b32 v148, v75, v4
    v_and_b32 v149, v75, v5
    v_and_b32 v150, v75, v6
    v_and_b32 v151, v75, v7
    v_mfma_f32_16x16x32_bf16 v[20:23], v[112:115], v[144:147], v[20:23]
    s_waitcnt lgkmcnt(0)
    v_and_b32 v152, v76, v4
    v_and_b32 v153, v76, v5
    v_and_b32 v154, v76, v6
    v_and_b32 v155, v76, v7
    v_mfma_f32_16x16x32_bf16 v[20:23], v[116:119], v[148:151], v[20:23]
    v_and_b32 v156, v77, v4
    v_and_b32 v157, v77, v5
    v_and_b32 v158, v77, v6
    v_and_b32 v159, v77, v7
    v_mfma_f32_16x16x32_bf16 v[20:23], v[120:123], v[152:155], v[20:23]
    v_and_b32 v160, v78, v4
    v_and_b32 v161, v78, v5
    v_and_b32 v162, v78, v6
    v_and_b32 v163, v78, v7
    v_mfma_f32_16x16x32_bf16 v[20:23], v[124:127], v[156:159], v[20:23]
    v_and_b32 v164, v79, v4
    v_and_b32 v165, v79, v5
    v_and_b32 v166, v79, v6
    v_and_b32 v167, v79, v7
    v_mfma_f32_16x16x32_bf16 v[20:23], v[128:131], v[160:163], v[20:23]
    s_nop 0
    v_mfma_f32_16x16x32_bf16 v[20:23], v[132:135], v[164:167], v[20:23]
    s_nop 7
    v_and_or_b32 v20, v20, s91, v244
    v_and_or_b32 v21, v21, s91, v245
    v_and_or_b32 v22, v22, s91, v246
    v_and_or_b32 v23, v23, s91, v247
    buffer_store_dwordx4 v[20:23], v2, s[32:35], s63 offen sc1
    s_cmp_lg_u32 s7, 0
    s_cbranch_scc1 L_fin
    s_lshr_b32 s86, s2, 3
    s_lshl_b32 s87, s86, 7
    s_lshl_b32 s88, s44, 18
    s_add_u32 s87, s87, s88
    s_and_b32 s3, s2, 0
    s_lshl_b32 s88, s3, 4
    s_add_u32 s87, s87, s88
    s_add_u32 s87, s87, 1310720
    v_and_b32 v34, 7, v3
    s_add_u32 s12, s87, 0
    s_add_u32 s13, s87, 32768
    s_add_u32 s14, s87, 65536
    s_add_u32 s15, s87, 98304
    s_add_u32 s16, s87, 131072
    s_add_u32 s17, s87, 163840
    s_add_u32 s18, s87, 196608
    s_add_u32 s19, s87, 229376
    s_cmp_lg_u32 s44, 3
    s_cbranch_scc1 Lnog2_62
    v_lshlrev_b32 v200, 16, v168
    v_and_b32 v201, 0xffff0000, v168
    v_lshlrev_b32 v202, 16, v172
    v_and_b32 v203, 0xffff0000, v172
    v_lshlrev_b32 v204, 16, v169
    v_and_b32 v205, 0xffff0000, v169
    v_lshlrev_b32 v206, 16, v173
    v_and_b32 v207, 0xffff0000, v173
    v_lshlrev_b32 v208, 16, v170
    v_and_b32 v209, 0xffff0000, v170
    v_lshlrev_b32 v210, 16, v174
    v_and_b32 v211, 0xffff0000, v174
    v_lshlrev_b32 v212, 16, v171
    v_and_b32 v213, 0xffff0000, v171
    v_lshlrev_b32 v214, 16, v175
    v_and_b32 v215, 0xffff0000, v175
    v_mul_f32 v200, v200, v202
    v_mul_f32 v201, v201, v203
    v_mul_f32 v204, v204, v206
    v_mul_f32 v205, v205, v207
    v_mul_f32 v208, v208, v210
    v_mul_f32 v209, v209, v211
    v_mul_f32 v212, v212, v214
    v_mul_f32 v213, v213, v215
    v_cvt_pk_bf16_f32 v200, v200, v201
    v_cvt_pk_bf16_f32 v204, v204, v205
    v_cvt_pk_bf16_f32 v208, v208, v209
    v_cvt_pk_bf16_f32 v212, v212, v213
    v_and_b32 v201, 0xffff0000, v200
    v_lshlrev_b32 v200, 16, v200
    v_and_b32 v205, 0xffff0000, v204
    v_lshlrev_b32 v204, 16, v204
    v_and_b32 v209, 0xffff0000, v208
    v_lshlrev_b32 v208, 16, v208
    v_and_b32 v213, 0xffff0000, v212
    v_lshlrev_b32 v212, 16, v212
    v_add_f32 v200, v200, v201
    v_add_f32 v204, v204, v205
    v_add_f32 v208, v208, v209
    v_add_f32 v212, v212, v213
    v_add_f32 v200, v200, v204
    v_add_f32 v208, v208, v212
    v_add_f32 v200, v200, v208
    s_nop 1
    v_add_f32_dpp v200, v200, v200 row_ror:1 row_mask:0xf bank_mask:0xf
    s_nop 1
    v_add_f32_dpp v200, v200, v200 row_ror:2 row_mask:0xf bank_mask:0xf
    s_nop 1
    v_add_f32_dpp v200, v200, v200 row_ror:4 row_mask:0xf bank_mask:0xf
    s_nop 1
    v_add_f32_dpp v200, v200, v200 row_ror:8 row_mask:0xf bank_mask:0xf
    v_mov_b32 v201, v200
    s_nop 1
    v_permlane16_swap_b32 v200, v201
    v_add_f32 v200, v200, v201
    v_mov_b32 v201, v200
    s_nop 1
    v_permlane32_swap_b32 v200, v201
    v_add_f32 v200, v200, v201
    v_cvt_pk_bf16_f32 v200, v200, v200
    v_and_b32 v200, 0xffff0000, v200
    v_mul_f32 v200, 0xbfb8aa3b, v200
    v_exp_f32 v200, v200
    s_nop 0
    v_add_f32 v200, 1.0, v200
    v_rcp_f32 v200, v200
    s_nop 0
    v_cvt_pk_bf16_f32 v200, v200, v200
    v_and_b32 v200, 0xffff0000, v200
    v_mov_b32 v201, 56320
    s_mov_b64 exec, 1
    ds_write_b32 v201, v200
    s_mov_b64 exec, -1
Lnog2_62:
    s_sleep 22
Lpoll_63:
    buffer_load_dwordx4 v[72:75], v255, s[32:35], s12 offen sc1
    buffer_load_dwordx4 v[76:79], v255, s[32:35], s13 offen sc1
    buffer_load_dwordx4 v[80:83], v255, s[32:35], s14 offen sc1
    buffer_load_dwordx4 v[84:87], v255, s[32:35], s15 offen sc1
    buffer_load_dwordx4 v[88:91], v255, s[32:35], s16 offen sc1
    buffer_load_dwordx4 v[92:95], v255, s[32:35], s17 offen sc1
    buffer_load_dwordx4 v[96:99], v255, s[32:35], s18 offen sc1
    buffer_load_dwordx4 v[100:103], v255, s[32:35], s19 offen sc1
    s_mov_b64 exec, -1
    s_sub_u32 s84, s84, 1
    s_cbranch_scc1 L_end
    s_waitcnt vmcnt(0)
    v_perm_b32 v36, v73, v72, s89
    v_perm_b32 v37, v75, v74, s90
    v_or_b32 v36, v36, v37
    v_xor_b32 v36, v36, v68
    v_perm_b32 v37, v77, v76, s89
    v_perm_b32 v38, v79, v78, s90
    v_or_b32 v37, v37, v38
    v_xor_b32 v37, v37, v68
    v_perm_b32 v38, v81, v80, s89
    v_perm_b32 v39, v83, v82, s90
    v_or_b32 v38, v38, v39
    v_xor_b32 v38, v38, v68
    v_perm_b32 v39, v85, v84, s89
    v_perm_b32 v40, v87, v86, s90
    v_or_b32 v39, v39, v40
    v_xor_b32 v39, v39, v68
    v_perm_b32 v40, v89, v88, s89
    v_perm_b32 v41, v91, v90, s90
    v_or_b32 v40, v40, v41
    v_xor_b32 v40, v40, v68
    v_perm_b32 v41, v93, v92, s89
    v_perm_b32 v42, v95, v94, s90
    v_or_b32 v41, v41, v42
    v_xor_b32 v41, v41, v68
    v_perm_b32 v42, v97, v96, s89
    v_perm_b32 v43, v99, v98, s90
    v_or_b32 v42, v42, v43
    v_xor_b32 v42, v42, v68
    v_perm_b32 v43, v101, v100, s89
    v_perm_b32 v44, v103, v102, s90
    v_or_b32 v43, v43, v44
    v_xor_b32 v43, v43, v68
    v_or_b32 v36, v36, v37
    v_or_b32 v36, v36, v38
    v_or_b32 v36, v36, v39
    v_or_b32 v36, v36, v40
    v_or_b32 v36, v36, v41
    v_or_b32 v36, v36, v42
    v_or_b32 v36, v36, v43
    v_cmp_ne_u32 vcc, 0, v36
    s_cbranch_vccz Lpok_64
    s_mov_b64 exec, vcc
    s_branch Lpoll_63
Lpok_64:
    v_add_f32 v72, v72, v88
    v_add_f32 v73, v73, v89
    v_add_f32 v74, v74, v90
    v_add_f32 v75, v75, v91
    v_add_f32 v76, v76, v92
    v_add_f32 v77, v77, v93
    v_add_f32 v78, v78, v94
    v_add_f32 v79, v79, v95
    v_add_f32 v80, v80, v96
    v_add_f32 v81, v81, v97
    v_add_f32 v82, v82, v98
    v_add_f32 v83, v83, v99
    v_add_f32 v84, v84, v100
    v_add_f32 v85, v85, v101
    v_add_f32 v86, v86, v102
    v_add_f32 v87, v87, v103
    v_add_f32 v72, v72, v80
    v_add_f32 v73, v73, v81
    v_add_f32 v74, v74, v82
    v_add_f32 v75, v75, v83
    v_add_f32 v76, v76, v84
    v_add_f32 v77, v77, v85
    v_add_f32 v78, v78, v86
    v_add_f32 v79, v79, v87
    v_add_f32 v72, v72, v76
    v_add_f32 v73, v73, v77
    v_add_f32 v74, v74, v78
    v_add_f32 v75, v75, v79
    s_nop 1
    v_permlane32_swap_b32 v72, v74
    v_permlane32_swap_b32 v73, v75
    v_add_f32 v72, v72, v74
    v_add_f32 v73, v73, v75
    s_nop 1
    v_permlane16_swap_b32 v72, v73
    v_add_f32 v72, v72, v73
    v_lshrrev_b32 v33, 4, v3
    v_lshlrev_b32 v33, 5, v33
    v_add_f32_dpp v72, v72, v72 row_ror:8 row_mask:0xf bank_mask:0xf
    v_lshl_add_u32 v33, v34, 2, v33
    s_lshl_b32 s87, s44, 7
    v_add_u32 v33, s87, v33
    s_mov_b32 exec_lo, 0xff00ff
    s_mov_b32 exec_hi, 0xff00ff
    ds_write_b32 v33, v72 offset:55808
    s_mov_b64 exec, -1
    v_and_b32 v34, 31, v3
    v_lshlrev_b32 v33, 2, v34
    v_add_u32 v35, 55808, v33
    v_mov_b32 v36, 56320
    s_lshr_b32 s87, s86, 1
    s_lshl_b32 s87, s87, 6
    s_and_b32 s88, s86, 1
    s_lshl_b32 s88, s88, 10
    s_add_u32 s87, s87, s88
    s_lshl_b32 s88, s3, 1
    s_add_u32 s87, s87, s88
    v_lshlrev_b32 v33, 1, v34
    s_waitcnt lgkmcnt(0)
    s_barrier
    s_cmp_lg_u32 s44, 0
    s_cbranch_scc1 L_fin
    ds_read2_b32 v[72:73], v35 offset0:0 offset1:64
    ds_read2_b32 v[74:75], v35 offset0:32 offset1:96
    ds_read_b32 v36, v36
    s_waitcnt lgkmcnt(0)
    v_add_f32 v72, v72, v74
    v_add_f32 v73, v73, v75
    v_sub_f32 v37, 1.0, v36
    v_cvt_pk_bf16_f32 v72, v72, v73
    v_cvt_pk_bf16_f32 v37, v37, v37
    v_and_b32 v73, 0xffff0000, v72
    v_lshlrev_b32 v72, 16, v72
    v_and_b32 v37, 0xffff0000, v37
    v_mul_f32 v72, v72, v36
    v_mul_f32 v73, v73, v37
    v_cvt_pk_bf16_f32 v72, v72, v73
    v_and_b32 v73, 0xffff0000, v72
    v_lshlrev_b32 v72, 16, v72
    v_add_f32 v72, v72, v73
    v_cvt_pk_bf16_f32 v72, v72, v72
    s_mov_b32 exec_hi, 0
    s_mov_b32 exec_lo, 0xffffffff
    buffer_store_short v72, v33, s[40:43], s87 offen sc1
    s_cmp_lg_u32 s2, 0
    s_cbranch_scc1 L_fin
    s_mov_b64 exec, 1
    v_mov_b32 v33, 0
    buffer_store_dword v68, v33, s[32:35], 0 offen sc1
L_fin:
L_end:
    s_endpgm
.section .rodata,"a"
.p2align 6
.amdhsa_kernel gated_mix__sliding_block_cached__gqa_block_cached__decode_kernel
  .amdhsa_next_free_vgpr 264
  .amdhsa_next_free_sgpr 102
  .amdhsa_accum_offset 256
  .amdhsa_group_segment_fixed_size 0
  .amdhsa_kernarg_size 112
  .amdhsa_user_sgpr_count 2
  .amdhsa_user_sgpr_kernarg_segment_ptr 1
  .amdhsa_system_sgpr_workgroup_id_x 1
.end_amdhsa_kernel
```
